```python
import torch

def _softmax(x, axis=-1):
    return torch.softmax(x, dim=axis)
def _gelu(x):
    return torch.nn.functional.gelu(x, approximate="tanh")
def _silu(x):
    return torch.nn.functional.silu(x)
def _sigmoid(x):
    return torch.sigmoid(x)
def _layernorm(x, axis=-1, eps=1e-5):
    m = x.mean(dim=axis, keepdim=True)
    v = x.var(dim=axis, keepdim=True, unbiased=False)
    return (x - m) / torch.sqrt(v + eps)
def _scatter_add(tgt, idx, src, axis=0):
    return tgt.clone().index_add_(axis, idx, src)
def _segment_sum(src, seg, n):
    out = torch.zeros((n,) + src.shape[1:], dtype=src.dtype)
    return out.index_add_(0, seg, src)
def _pad(x, pw):
    flat = tuple(v for pair in reversed(pw) for v in pair)
    return torch.nn.functional.pad(x, flat)

kernel_name = 'concat_heads__softmax_full_mha__linear_attn_block__prompt'

def setup_inputs():

    _w = (lambda a: (lambda t: t.to(torch.bfloat16) if t.is_floating_point() else t)(torch.as_tensor(a)))
    def _A_setup():
        B, S, D = 1, 2048, 448
        return {
            "x": _w((lambda *s: torch.randn(*s, dtype=torch.bfloat16) * 0.2)(B, S, D)),
            "wqkv": _w((lambda *s: torch.randn(*s, dtype=torch.bfloat16) * 0.2)(D, 3 * D)),
            "wo": _w((lambda *s: torch.randn(*s, dtype=torch.bfloat16) * 0.05)(D, D)),
        }
    _A_in = _A_setup()

    def _B_setup():
        B, S, D = 1, 2048, 448
        return {
            "x": _w((lambda *s: torch.randn(*s, dtype=torch.bfloat16) * 0.05)(B, S, D)),
            "wqkv": _w((lambda *s: torch.randn(*s, dtype=torch.bfloat16) * 1.6)(D, 3 * D)),
            "wo": _w((lambda *s: torch.randn(*s, dtype=torch.bfloat16) * 0.05)(D, D)),
        }
    _B_in = _B_setup()

    return {
        "A_x": _A_in["x"],
        "A_wqkv": _A_in["wqkv"],
        "A_wo": _A_in["wo"],
        "B_x": _B_in["x"],
        "B_wqkv": _B_in["wqkv"],
        "B_wo": _B_in["wo"],
    }

def reference(A_x, A_wqkv, A_wo, B_x, B_wqkv, B_wo):
    def _A_ref(x, wqkv, wo):
        B, S, D = x.shape
        H = 16; Dh = D // H
        qkv = (lambda x, *d: x.permute(*d))((x @ wqkv).reshape(B, S, 3, H, Dh), 2, 0, 3, 1, 4)
        q, k, v = qkv[0], qkv[1], qkv[2]
        scale = Dh ** -0.5
        scores = torch.einsum("bhqd,bhkd->bhqk", q, k) * scale
        p = _softmax(scores, axis=-1)
        o = torch.einsum("bhqk,bhkd->bhqd", p, v)
        return (lambda x, *d: x.permute(*d))(o, 0, 2, 1, 3).reshape(B, S, D) @ wo

    def _B_ref(x, wqkv, wo):
        B, S, D = x.shape
        H = 16; Dh = D // H
        qkv = (lambda x, *d: x.permute(*d))((x @ wqkv).reshape(B, S, 3, H, Dh), 2, 0, 3, 1, 4)
        q, k, v = qkv[0], qkv[1], qkv[2]
        phi = lambda t: torch.where(t > 0, t + 1, torch.exp(t)) + 1e-6
        pq, pk = phi(q), phi(k)
        kv = torch.einsum("bhsd,bhse->bhde", pk, v)
        z = torch.einsum("bhsd->bhd", pk)
        num = torch.einsum("bhqd,bhde->bhqe", pq, kv)
        den = torch.einsum("bhqd,bhd->bhq", pq, z)[..., None] + 1e-6
        o = num / den
        return (lambda x, *d: x.permute(*d))(o, 0, 2, 1, 3).reshape(B, S, D) @ wo

    a = _A_ref(A_x, A_wqkv, A_wo)
    b = _B_ref(B_x, B_wqkv, B_wo)
    return torch.concatenate([a, b], axis=-1)
```

```asm
; @launch grid=(256,1,1) block=(512,1,1) lds=163840
.amdgcn_target "amdgcn-amd-amdhsa--gfx950"
.text
.globl concat_heads__softmax_full_mha__linear_attn_block__prompt_kernel
.p2align 8
.type concat_heads__softmax_full_mha__linear_attn_block__prompt_kernel,@function
concat_heads__softmax_full_mha__linear_attn_block__prompt_kernel:
  s_cmp_ge_u32 s2, 256
  s_cbranch_scc1 L_END
  s_load_dwordx8 s[4:11], s[0:1], 0
  s_load_dwordx4 s[12:15], s[0:1], 32
  s_load_dwordx4 s[64:67], s[0:1], 48
  s_load_dwordx2 s[68:69], s[0:1], 64
  s_memrealtime s[50:51]
  v_lshrrev_b32 v2, 6, v0
  v_and_b32 v1, 63, v0
  s_and_b32 s32, s2, 7
  s_lshr_b32 s30, s2, 3
  v_readfirstlane_b32 s31, v2
  s_mul_i32 s34, s30, 37
  s_lshr_b32 s34, s34, 8
  s_mul_i32 s35, s34, 7
  s_sub_u32 s54, s30, s35
  s_lshl_b32 s33, s32, 2
  s_add_u32 s53, s33, s34
  s_and_b32 s28, s32, 1
  s_lshr_b32 s33, s32, 1
  s_lshl_b32 s33, s33, 2
  s_add_u32 s58, s33, s34
  s_and_b32 s60, s31, 3
  s_lshr_b32 s61, s31, 2
  s_and_b32 s57, s31, 1
  s_lshl_b32 s35, s34, 1
  s_add_u32 s35, s35, s54
  s_cmp_ge_u32 s35, 7
  s_cselect_b32 s36, 7, 0
  s_sub_u32 s35, s35, s36
  s_cmp_ge_u32 s35, 7
  s_cselect_b32 s36, 7, 0
  s_sub_u32 s40, s35, s36
  v_lshrrev_b32 v5, 3, v1
  v_and_b32 v6, 7, v1
  v_lshrrev_b32 v11, 1, v5
  v_xor_b32 v12, v6, v11
  s_lshl_b32 s34, s58, 7
  s_lshl_b32 s33, s60, 5
  s_add_u32 s34, s34, s33
  v_add_u32 v10, s34, v5
  v_mul_u32_u24 v10, 896, v10
  v_lshl_add_u32 v96, v12, 4, v10
  v_xor_b32 v12, 4, v12
  v_lshl_add_u32 v97, v12, 4, v10
  v_add_u32 v97, 7168, v97
  v_add_u32 v98, 14336, v96
  v_add_u32 v99, 14336, v97
  s_lshl_b32 s35, s60, 4
  v_add_u32 v7, s35, v5
  v_mul_u32_u24 v10, 2688, v7
  v_and_b32 v11, 1, v11
  v_lshlrev_b32 v11, 2, v11
  v_xor_b32 v11, v6, v11
  v_lshl_add_u32 v3, v11, 4, v10
  s_lshl_b32 s34, s54, 7
  v_add_u32 v3, s34, v3
  s_lshl_b32 s36, s31, 10
  s_lshl_b32 s37, s60, 12
  s_lshl_b32 s59, s60, 11
  s_lshl_b32 s35, s31, 3
  v_add_u32 v7, s35, v5
  v_mul_u32_u24 v10, 896, v7
  v_lshl_add_u32 v4, v11, 4, v10
  v_add_u32 v4, s34, v4
  v_lshlrev_b32 v8, 4, v1
  v_mov_b32 v9, 0
  v_lshlrev_b32 v13, 2, v1
  s_waitcnt lgkmcnt(0)
  s_cmp_eq_u32 s28, 0
  s_cselect_b32 s4, s4, s10
  s_cselect_b32 s5, s5, s11
  s_cselect_b32 s6, s6, s12
  s_cselect_b32 s7, s7, s13
  s_movk_i32 s41, 896
  s_movk_i32 s42, 1792
  s_mov_b32 s43, 0
  s_mov_b32 s16, s4
  s_and_b32 s17, s5, 0xffff
  s_mov_b32 s18, 1835008
  s_mov_b32 s19, 0x20000
  s_mov_b32 s20, s6
  s_and_b32 s21, s7, 0xffff
  s_mov_b32 s22, 1204224
  s_mov_b32 s23, 0x20000
  s_cmp_ge_u32 s30, 28
  s_cbranch_scc1 L_A0
  s_cmp_lt_u32 s31, 4
  s_cbranch_scc1 L_A0
  s_lshl_b32 s38, s40, 7
  s_mul_i32 s39, s40, 172032
  s_add_u32 s40, s40, 1
  s_cmp_eq_u32 s40, 7
  s_cselect_b32 s40, 0, s40
  s_add_u32 m0, s59, 114688
  s_add_u32 s39, s39, s41
  buffer_load_dwordx4 v3, s[20:23], s39 offen lds
  s_add_u32 m0, s59, 115712
  s_add_u32 s39, s39, 21504
  buffer_load_dwordx4 v3, s[20:23], s39 offen lds
  s_add_u32 m0, s37, 0
  s_nop 0
  buffer_load_dwordx4 v96, s[16:19], s38 offen lds
  s_add_u32 m0, s37, 1024
  s_nop 0
  buffer_load_dwordx4 v97, s[16:19], s38 offen lds
  s_add_u32 m0, s37, 2048
  s_nop 0
  buffer_load_dwordx4 v98, s[16:19], s38 offen lds
  s_add_u32 m0, s37, 3072
  s_nop 0
  buffer_load_dwordx4 v99, s[16:19], s38 offen lds
L_A0:
  s_mov_b32 s24, s68
  s_and_b32 s25, s69, 0xffff
  s_mov_b32 s26, 18874368
  s_mov_b32 s27, 0x20000
  s_mov_b32 s44, s66
  s_and_b32 s45, s67, 0xffff
  s_mov_b32 s46, 256
  s_mov_b32 s47, 0x20000
  s_and_b32 s55, s30, 1
  s_lshl_b32 s33, s32, 1
  s_add_u32 s55, s55, s33
  s_lshr_b32 s56, s30, 1
  s_mul_i32 s33, s55, 7
  s_lshr_b32 s29, s33, 1
  s_lshl_b32 s29, s29, 9
  s_lshl_b32 s34, s61, 3
  s_add_u32 s34, s34, s56
  s_and_b32 s34, s34, 15
  s_lshl_b32 s35, s60, 4
  s_add_u32 s34, s34, s35
  s_lshl_b32 s70, s34, 15
  s_add_u32 s70, s70, s29
  s_add_u32 s70, s70, 2097152
  s_lshl_b32 s71, s55, 6
  s_add_u32 s71, s71, s34
  s_lshl_b32 s71, s71, 11
  s_add_u32 s71, s71, 4194304
  s_lshr_b32 s34, s33, 4
  s_add_u32 s35, s33, 6
  s_lshr_b32 s35, s35, 4
  s_sub_u32 s35, s35, s34
  s_lshl_b32 s34, s34, 11
  s_add_u32 s34, s34, 17891328
  s_lshl_b32 s35, s35, 11
  v_and_b32 v10, 15, v1
  v_lshlrev_b32 v10, 7, v10
  v_bfe_u32 v11, v1, 4, 1
  v_mul_u32_u24 v11, s35, v11
  v_add3_u32 v158, v10, v11, s34
  s_add_u32 s34, s34, 16384
  s_lshl_b32 s35, s56, 7
  s_add_u32 s35, s35, s34
  s_lshl_b32 s33, s55, 7
  s_add_u32 s34, s34, s33
  s_cmp_eq_u32 s31, 7
  s_cselect_b32 exec_hi, -1, 0
  s_mov_b32 exec_lo, 0
  v_add_u32 v158, s35, v11
  s_cselect_b32 exec_lo, -1, 0
  s_mov_b32 exec_hi, 0
  v_mov_b32 v158, s34
  s_mov_b64 exec, -1
  s_lshr_b32 s34, s53, 1
  s_and_b32 s34, s34, 15
  s_lshl_b32 s34, s34, 10
  s_add_u32 s34, s34, 17858560
  v_add_u32 v0, s34, v8
  s_or_b32 s50, s50, 1
  s_lshl_b32 s34, s2, 3
  s_add_u32 s34, s34, s31
  s_cmp_lg_u32 s34, 2040
  s_cbranch_scc1 L_NN
  v_mov_b32 v6, s50
  v_mov_b32 v7, s51
  s_mov_b64 exec, 1
  buffer_store_dwordx2 v[6:7], v9, s[44:47], 0 offen sc1
  s_mov_b64 exec, -1
L_NN:
  s_cmp_ge_u32 s30, 28
  s_cbranch_scc1 L_IDLE
  s_cmp_lt_u32 s31, 4
  s_cbranch_scc1 L_CMP
  s_lshl_b32 s38, s40, 7
  s_mul_i32 s39, s40, 172032
  s_add_u32 s40, s40, 1
  s_cmp_eq_u32 s40, 7
  s_cselect_b32 s40, 0, s40
  s_add_u32 m0, s59, 122880
  s_add_u32 s39, s39, s41
  buffer_load_dwordx4 v3, s[20:23], s39 offen lds
  s_add_u32 m0, s59, 123904
  s_add_u32 s39, s39, 21504
  buffer_load_dwordx4 v3, s[20:23], s39 offen lds
  s_add_u32 m0, s37, 16384
  s_nop 0
  buffer_load_dwordx4 v96, s[16:19], s38 offen lds
  s_add_u32 m0, s37, 17408
  s_nop 0
  buffer_load_dwordx4 v97, s[16:19], s38 offen lds
  s_add_u32 m0, s37, 18432
  s_nop 0
  buffer_load_dwordx4 v98, s[16:19], s38 offen lds
  s_add_u32 m0, s37, 19456
  s_nop 0
  buffer_load_dwordx4 v99, s[16:19], s38 offen lds
  s_waitcnt vmcnt(6)
  s_barrier
  s_lshl_b32 s38, s40, 7
  s_mul_i32 s39, s40, 172032
  s_add_u32 s40, s40, 1
  s_cmp_eq_u32 s40, 7
  s_cselect_b32 s40, 0, s40
  s_add_u32 m0, s59, 131072
  s_add_u32 s39, s39, s41
  buffer_load_dwordx4 v3, s[20:23], s39 offen lds
  s_add_u32 m0, s59, 132096
  s_add_u32 s39, s39, 21504
  buffer_load_dwordx4 v3, s[20:23], s39 offen lds
  s_add_u32 m0, s37, 32768
  s_nop 0
  buffer_load_dwordx4 v96, s[16:19], s38 offen lds
  s_add_u32 m0, s37, 33792
  s_nop 0
  buffer_load_dwordx4 v97, s[16:19], s38 offen lds
  s_add_u32 m0, s37, 34816
  s_nop 0
  buffer_load_dwordx4 v98, s[16:19], s38 offen lds
  s_add_u32 m0, s37, 35840
  s_nop 0
  buffer_load_dwordx4 v99, s[16:19], s38 offen lds
  s_waitcnt vmcnt(6)
  s_barrier
  s_lshl_b32 s38, s40, 7
  s_mul_i32 s39, s40, 172032
  s_add_u32 s40, s40, 1
  s_cmp_eq_u32 s40, 7
  s_cselect_b32 s40, 0, s40
  s_add_u32 m0, s59, 139264
  s_add_u32 s39, s39, s41
  buffer_load_dwordx4 v3, s[20:23], s39 offen lds
  s_add_u32 m0, s59, 140288
  s_add_u32 s39, s39, 21504
  buffer_load_dwordx4 v3, s[20:23], s39 offen lds
  s_add_u32 m0, s37, 49152
  s_nop 0
  buffer_load_dwordx4 v96, s[16:19], s38 offen lds
  s_add_u32 m0, s37, 50176
  s_nop 0
  buffer_load_dwordx4 v97, s[16:19], s38 offen lds
  s_add_u32 m0, s37, 51200
  s_nop 0
  buffer_load_dwordx4 v98, s[16:19], s38 offen lds
  s_add_u32 m0, s37, 52224
  s_nop 0
  buffer_load_dwordx4 v99, s[16:19], s38 offen lds
  s_waitcnt vmcnt(6)
  s_barrier
  s_lshl_b32 s38, s40, 7
  s_mul_i32 s39, s40, 172032
  s_add_u32 s40, s40, 1
  s_cmp_eq_u32 s40, 7
  s_cselect_b32 s40, 0, s40
  s_add_u32 m0, s59, 147456
  s_add_u32 s39, s39, s41
  buffer_load_dwordx4 v3, s[20:23], s39 offen lds
  s_add_u32 m0, s59, 148480
  s_add_u32 s39, s39, 21504
  buffer_load_dwordx4 v3, s[20:23], s39 offen lds
  s_add_u32 m0, s37, 65536
  s_nop 0
  buffer_load_dwordx4 v96, s[16:19], s38 offen lds
  s_add_u32 m0, s37, 66560
  s_nop 0
  buffer_load_dwordx4 v97, s[16:19], s38 offen lds
  s_add_u32 m0, s37, 67584
  s_nop 0
  buffer_load_dwordx4 v98, s[16:19], s38 offen lds
  s_add_u32 m0, s37, 68608
  s_nop 0
  buffer_load_dwordx4 v99, s[16:19], s38 offen lds
  s_waitcnt vmcnt(6)
  s_barrier
  s_lshl_b32 s38, s40, 7
  s_mul_i32 s39, s40, 172032
  s_add_u32 s40, s40, 1
  s_cmp_eq_u32 s40, 7
  s_cselect_b32 s40, 0, s40
  s_add_u32 m0, s59, 155648
  s_add_u32 s39, s39, s41
  buffer_load_dwordx4 v3, s[20:23], s39 offen lds
  s_add_u32 m0, s59, 156672
  s_add_u32 s39, s39, 21504
  buffer_load_dwordx4 v3, s[20:23], s39 offen lds
  s_add_u32 m0, s37, 81920
  s_nop 0
  buffer_load_dwordx4 v96, s[16:19], s38 offen lds
  s_add_u32 m0, s37, 82944
  s_nop 0
  buffer_load_dwordx4 v97, s[16:19], s38 offen lds
  s_add_u32 m0, s37, 83968
  s_nop 0
  buffer_load_dwordx4 v98, s[16:19], s38 offen lds
  s_add_u32 m0, s37, 84992
  s_nop 0
  buffer_load_dwordx4 v99, s[16:19], s38 offen lds
  s_waitcnt vmcnt(6)
  s_barrier
  s_lshl_b32 s38, s40, 7
  s_mul_i32 s39, s40, 172032
  s_add_u32 s40, s40, 1
  s_cmp_eq_u32 s40, 7
  s_cselect_b32 s40, 0, s40
  s_add_u32 m0, s59, 114688
  s_add_u32 s39, s39, s41
  buffer_load_dwordx4 v3, s[20:23], s39 offen lds
  s_add_u32 m0, s59, 115712
  s_add_u32 s39, s39, 21504
  buffer_load_dwordx4 v3, s[20:23], s39 offen lds
  s_add_u32 m0, s37, 98304
  s_nop 0
  buffer_load_dwordx4 v96, s[16:19], s38 offen lds
  s_add_u32 m0, s37, 99328
  s_nop 0
  buffer_load_dwordx4 v97, s[16:19], s38 offen lds
  s_add_u32 m0, s37, 100352
  s_nop 0
  buffer_load_dwordx4 v98, s[16:19], s38 offen lds
  s_add_u32 m0, s37, 101376
  s_nop 0
  buffer_load_dwordx4 v99, s[16:19], s38 offen lds
  s_waitcnt vmcnt(6)
  s_barrier
  s_lshl_b32 s38, s40, 7
  s_mul_i32 s39, s40, 172032
  s_add_u32 s40, s40, 1
  s_cmp_eq_u32 s40, 7
  s_cselect_b32 s40, 0, s40
  s_add_u32 m0, s59, 122880
  s_add_u32 s39, s39, s42
  buffer_load_dwordx4 v3, s[20:23], s39 offen lds
  s_add_u32 m0, s59, 123904
  s_add_u32 s39, s39, 21504
  buffer_load_dwordx4 v3, s[20:23], s39 offen lds
  s_lshl_b32 s38, s40, 7
  s_mul_i32 s39, s40, 172032
  s_add_u32 s40, s40, 1
  s_cmp_eq_u32 s40, 7
  s_cselect_b32 s40, 0, s40
  s_add_u32 m0, s59, 131072
  s_add_u32 s39, s39, s42
  buffer_load_dwordx4 v3, s[20:23], s39 offen lds
  s_add_u32 m0, s59, 132096
  s_add_u32 s39, s39, 21504
  buffer_load_dwordx4 v3, s[20:23], s39 offen lds
  s_waitcnt vmcnt(4)
  s_barrier
  s_lshl_b32 s38, s40, 7
  s_mul_i32 s39, s40, 172032
  s_add_u32 s40, s40, 1
  s_cmp_eq_u32 s40, 7
  s_cselect_b32 s40, 0, s40
  s_add_u32 m0, s59, 139264
  s_add_u32 s39, s39, s42
  buffer_load_dwordx4 v3, s[20:23], s39 offen lds
  s_add_u32 m0, s59, 140288
  s_add_u32 s39, s39, 21504
  buffer_load_dwordx4 v3, s[20:23], s39 offen lds
  s_lshl_b32 s38, s40, 7
  s_mul_i32 s39, s40, 172032
  s_add_u32 s40, s40, 1
  s_cmp_eq_u32 s40, 7
  s_cselect_b32 s40, 0, s40
  s_add_u32 m0, s59, 147456
  s_add_u32 s39, s39, s42
  buffer_load_dwordx4 v3, s[20:23], s39 offen lds
  s_add_u32 m0, s59, 148480
  s_add_u32 s39, s39, 21504
  buffer_load_dwordx4 v3, s[20:23], s39 offen lds
  s_waitcnt vmcnt(4)
  s_barrier
  s_lshl_b32 s38, s40, 7
  s_mul_i32 s39, s40, 172032
  s_add_u32 s40, s40, 1
  s_cmp_eq_u32 s40, 7
  s_cselect_b32 s40, 0, s40
  s_add_u32 m0, s59, 155648
  s_add_u32 s39, s39, s42
  buffer_load_dwordx4 v3, s[20:23], s39 offen lds
  s_add_u32 m0, s59, 156672
  s_add_u32 s39, s39, 21504
  buffer_load_dwordx4 v3, s[20:23], s39 offen lds
  s_lshl_b32 s38, s40, 7
  s_mul_i32 s39, s40, 172032
  s_add_u32 s40, s40, 1
  s_cmp_eq_u32 s40, 7
  s_cselect_b32 s40, 0, s40
  s_add_u32 m0, s59, 114688
  s_add_u32 s39, s39, s42
  buffer_load_dwordx4 v3, s[20:23], s39 offen lds
  s_add_u32 m0, s59, 115712
  s_add_u32 s39, s39, 21504
  buffer_load_dwordx4 v3, s[20:23], s39 offen lds
  s_waitcnt vmcnt(4)
  s_barrier
  s_lshl_b32 s38, s40, 7
  s_mul_i32 s39, s40, 172032
  s_add_u32 s40, s40, 1
  s_cmp_eq_u32 s40, 7
  s_cselect_b32 s40, 0, s40
  s_add_u32 m0, s59, 122880
  s_add_u32 s39, s39, s42
  buffer_load_dwordx4 v3, s[20:23], s39 offen lds
  s_add_u32 m0, s59, 123904
  s_add_u32 s39, s39, 21504
  buffer_load_dwordx4 v3, s[20:23], s39 offen lds
  s_lshl_b32 s38, s40, 7
  s_mul_i32 s39, s40, 172032
  s_add_u32 s40, s40, 1
  s_cmp_eq_u32 s40, 7
  s_cselect_b32 s40, 0, s40
  s_add_u32 m0, s59, 131072
  s_add_u32 s39, s39, s43
  buffer_load_dwordx4 v3, s[20:23], s39 offen lds
  s_add_u32 m0, s59, 132096
  s_add_u32 s39, s39, 21504
  buffer_load_dwordx4 v3, s[20:23], s39 offen lds
  s_waitcnt vmcnt(4)
  s_barrier
  s_lshl_b32 s38, s40, 7
  s_mul_i32 s39, s40, 172032
  s_add_u32 s40, s40, 1
  s_cmp_eq_u32 s40, 7
  s_cselect_b32 s40, 0, s40
  s_add_u32 m0, s59, 139264
  s_add_u32 s39, s39, s43
  buffer_load_dwordx4 v3, s[20:23], s39 offen lds
  s_add_u32 m0, s59, 140288
  s_add_u32 s39, s39, 21504
  buffer_load_dwordx4 v3, s[20:23], s39 offen lds
  s_lshl_b32 s38, s40, 7
  s_mul_i32 s39, s40, 172032
  s_add_u32 s40, s40, 1
  s_cmp_eq_u32 s40, 7
  s_cselect_b32 s40, 0, s40
  s_add_u32 m0, s59, 147456
  s_add_u32 s39, s39, s43
  buffer_load_dwordx4 v3, s[20:23], s39 offen lds
  s_add_u32 m0, s59, 148480
  s_add_u32 s39, s39, 21504
  buffer_load_dwordx4 v3, s[20:23], s39 offen lds
  s_waitcnt vmcnt(4)
  s_barrier
  s_lshl_b32 s38, s40, 7
  s_mul_i32 s39, s40, 172032
  s_add_u32 s40, s40, 1
  s_cmp_eq_u32 s40, 7
  s_cselect_b32 s40, 0, s40
  s_add_u32 m0, s59, 155648
  s_add_u32 s39, s39, s43
  buffer_load_dwordx4 v3, s[20:23], s39 offen lds
  s_add_u32 m0, s59, 156672
  s_add_u32 s39, s39, 21504
  buffer_load_dwordx4 v3, s[20:23], s39 offen lds
  s_lshl_b32 s38, s40, 7
  s_mul_i32 s39, s40, 172032
  s_add_u32 s40, s40, 1
  s_cmp_eq_u32 s40, 7
  s_cselect_b32 s40, 0, s40
  s_add_u32 m0, s59, 114688
  s_add_u32 s39, s39, s43
  buffer_load_dwordx4 v3, s[20:23], s39 offen lds
  s_add_u32 m0, s59, 115712
  s_add_u32 s39, s39, 21504
  buffer_load_dwordx4 v3, s[20:23], s39 offen lds
  s_waitcnt vmcnt(4)
  s_barrier
  s_lshl_b32 s38, s40, 7
  s_mul_i32 s39, s40, 172032
  s_add_u32 s40, s40, 1
  s_cmp_eq_u32 s40, 7
  s_cselect_b32 s40, 0, s40
  s_add_u32 m0, s59, 122880
  s_add_u32 s39, s39, s43
  buffer_load_dwordx4 v3, s[20:23], s39 offen lds
  s_add_u32 m0, s59, 123904
  s_add_u32 s39, s39, 21504
  buffer_load_dwordx4 v3, s[20:23], s39 offen lds
  s_lshl_b32 s38, s40, 7
  s_mul_i32 s39, s40, 172032
  s_add_u32 s40, s40, 1
  s_cmp_eq_u32 s40, 7
  s_cselect_b32 s40, 0, s40
  s_add_u32 m0, s59, 131072
  s_add_u32 s39, s39, s43
  buffer_load_dwordx4 v3, s[20:23], s39 offen lds
  s_add_u32 m0, s59, 132096
  s_add_u32 s39, s39, 21504
  buffer_load_dwordx4 v3, s[20:23], s39 offen lds
  s_waitcnt vmcnt(4)
  s_barrier
  s_waitcnt vmcnt(0)
  s_barrier
  buffer_load_dwordx2 v[156:157], v9, s[44:47], 0 offen sc1
  s_waitcnt vmcnt(0)
  v_readfirstlane_b32 s50, v156
  v_readfirstlane_b32 s51, v157
  s_mov_b32 s52, 20000
LN1:
  s_cmp_lg_u32 s50, 0
  s_cbranch_scc1 LN2
  s_sub_u32 s52, s52, 1
  s_cmp_eq_u32 s52, 0
  s_cbranch_scc1 LN2
  buffer_load_dwordx2 v[156:157], v9, s[44:47], 0 offen sc1
  s_waitcnt vmcnt(0)
  v_readfirstlane_b32 s50, v156
  v_readfirstlane_b32 s51, v157
  s_branch LN1
LN2:
  s_mov_b32 s16, s8
  s_and_b32 s17, s9, 0xffff
  s_mov_b32 s18, 401408
  s_mov_b32 s19, 0x20000
  s_mov_b32 s20, s14
  s_and_b32 s21, s15, 0xffff
  s_mov_b32 s22, 401408
  s_mov_b32 s23, 0x20000
  s_barrier
  s_branch L_ATT
L_CMP:
  s_lshl_b32 s41, s58, 2
  s_add_u32 s41, s41, s60
  s_lshl_b32 s34, s54, 4
  s_add_u32 s35, s34, 22
  s_add_u32 s34, s34, 6
  s_mul_i32 s34, s34, 9363
  s_lshr_b32 s34, s34, 16
  s_mul_i32 s35, s35, 9363
  s_lshr_b32 s35, s35, 16
  s_sub_u32 s35, s35, s34
  v_mov_b32 v16, 0
  v_mov_b32 v20, 0x3f803f80
  v_mov_b32 v17, 0
  v_mov_b32 v21, 0x3f803f80
  v_mov_b32 v18, 0
  v_mov_b32 v22, 0x3f803f80
  v_mov_b32 v19, 0
  v_mov_b32 v23, 0x3f803f80
  v_lshrrev_b32 v5, 4, v1
  v_lshlrev_b32 v5, 17, v5
  v_bfe_u32 v6, v1, 2, 2
  v_lshl_add_u32 v5, v6, 9, v5
  v_and_b32 v6, 3, v1
  v_lshl_add_u32 v5, v6, 4, v5
  v_mul_u32_u24 v6, 7296, v1
  s_lshl_b32 s38, s34, 17
  s_lshl_b32 s39, s41, 11
  s_add_u32 s38, s38, s39
  s_add_u32 s38, s38, 4194752
  s_mul_i32 s39, s41, 29184
  s_lshl_b32 s42, s54, 4
  s_add_u32 s39, s39, s42
  s_add_u32 s39, s39, 10492928
  s_cmp_eq_u32 s35, 3
  s_cselect_b32 s49, 0xffff, 0
  s_cmp_eq_u32 s28, 0
  s_cselect_b32 s38, s38, s39
  s_cselect_b32 s48, -1, 15
  s_cselect_b32 s49, s49, 0
  s_cselect_b64 s[42:43], -1, 0
  v_cndmask_b32 v5, v6, v5, s[42:43]
  s_mov_b64 exec, s[48:49]
  buffer_store_dwordx4 v[20:23], v5, s[24:27], s38 offen sc1
  s_mov_b64 exec, -1
  s_add_u32 s34, s34, s60
  s_cmp_lt_u32 s60, s35
  s_cselect_b32 s38, s28, 0
  s_cmp_eq_u32 s34, s58
  s_cselect_b32 s38, s38, 0
  s_cmp_eq_u32 s38, 0
  s_cbranch_scc1 L_NZ
  s_lshl_b32 s38, s34, 12
  s_add_u32 s38, s38, 16777216
  s_lshl_b32 s39, s34, 7
  s_add_u32 s39, s39, 16842752
  buffer_store_dwordx4 v[16:19], v8, s[24:27], s38 offen offset:0 sc1
  buffer_store_dwordx4 v[16:19], v8, s[24:27], s38 offen offset:1024 sc1
  buffer_store_dwordx4 v[16:19], v8, s[24:27], s38 offen offset:2048 sc1
  buffer_store_dwordx4 v[16:19], v8, s[24:27], s38 offen offset:3072 sc1
  s_mov_b64 exec, 1
  buffer_store_dwordx4 v[16:19], v9, s[24:27], s39 offen sc1
  s_mov_b64 exec, -1
L_NZ:
  s_lshr_b32 s43, s31, 1
  s_lshl_b32 s41, s58, 1
  s_add_u32 s41, s41, s57
  s_lshl_b32 s41, s41, 1
  s_lshl_b32 s42, s54, 1
  s_add_u32 s42, s42, s43
  v_and_b32 v5, 31, v1
  v_lshrrev_b32 v6, 5, v1
  s_lshl_b32 s34, s57, 6
  v_add_u32 v7, s34, v5
  v_bfe_u32 v10, v7, 1, 3
  v_xor_b32 v10, v10, v6
  v_lshlrev_b32 v7, 7, v7
  v_xor_b32 v11, 0, v10
  v_lshl_add_u32 v160, v11, 4, v7
  v_add_u32 v165, 65536, v160
  v_xor_b32 v11, 2, v10
  v_lshl_add_u32 v161, v11, 4, v7
  v_add_u32 v166, 65536, v161
  v_xor_b32 v11, 4, v10
  v_lshl_add_u32 v162, v11, 4, v7
  v_add_u32 v167, 65536, v162
  v_xor_b32 v11, 6, v10
  v_lshl_add_u32 v163, v11, 4, v7
  v_add_u32 v168, 65536, v163
  v_bfe_u32 v7, v1, 2, 2
  v_lshl_add_u32 v10, v6, 3, v7
  v_lshlrev_b32 v10, 7, v10
  v_bfe_u32 v11, v1, 4, 1
  v_lshlrev_b32 v11, 5, v11
  v_and_b32 v12, 3, v1
  v_lshl_add_u32 v11, v12, 3, v11
  s_lshl_b32 s34, s43, 6
  v_add_u32 v11, s34, v11
  v_lshrrev_b32 v7, 1, v7
  v_lshlrev_b32 v7, 6, v7
  v_xor_b32 v11, v11, v7
  s_mov_b32 s34, 114688
  v_add3_u32 v164, v10, v11, s34
  s_cmp_eq_u32 s28, 0
  s_cselect_b32 s34, 0, 897988541
  v_mov_b32 v16, s34
  v_mov_b32 v17, s34
  v_mov_b32 v18, s34
  v_mov_b32 v19, s34
  v_mov_b32 v20, s34
  v_mov_b32 v21, s34
  v_mov_b32 v22, s34
  v_mov_b32 v23, s34
  v_mov_b32 v24, s34
  v_mov_b32 v25, s34
  v_mov_b32 v26, s34
  v_mov_b32 v27, s34
  v_mov_b32 v28, s34
  v_mov_b32 v29, s34
  v_mov_b32 v30, s34
  v_mov_b32 v31, s34
  v_mov_b32 v32, s34
  v_mov_b32 v33, s34
  v_mov_b32 v34, s34
  v_mov_b32 v35, s34
  v_mov_b32 v36, s34
  v_mov_b32 v37, s34
  v_mov_b32 v38, s34
  v_mov_b32 v39, s34
  v_mov_b32 v40, s34
  v_mov_b32 v41, s34
  v_mov_b32 v42, s34
  v_mov_b32 v43, s34
  v_mov_b32 v44, s34
  v_mov_b32 v45, s34
  v_mov_b32 v46, s34
  v_mov_b32 v47, s34
  v_mov_b32 v48, s34
  v_mov_b32 v49, s34
  v_mov_b32 v50, s34
  v_mov_b32 v51, s34
  v_mov_b32 v52, s34
  v_mov_b32 v53, s34
  v_mov_b32 v54, s34
  v_mov_b32 v55, s34
  v_mov_b32 v56, s34
  v_mov_b32 v57, s34
  v_mov_b32 v58, s34
  v_mov_b32 v59, s34
  v_mov_b32 v60, s34
  v_mov_b32 v61, s34
  v_mov_b32 v62, s34
  v_mov_b32 v63, s34
  v_mov_b32 v64, s34
  v_mov_b32 v65, s34
  v_mov_b32 v66, s34
  v_mov_b32 v67, s34
  v_mov_b32 v68, s34
  v_mov_b32 v69, s34
  v_mov_b32 v70, s34
  v_mov_b32 v71, s34
  v_mov_b32 v72, s34
  v_mov_b32 v73, s34
  v_mov_b32 v74, s34
  v_mov_b32 v75, s34
  v_mov_b32 v76, s34
  v_mov_b32 v77, s34
  v_mov_b32 v78, s34
  v_mov_b32 v79, s34
  s_lshl_b32 s34, s42, 5
  v_add_u32 v152, s34, v5
  v_mul_u32_u24 v10, 2341, v152
  v_lshrrev_b32 v10, 16, v10
  v_mul_u32_u24 v11, 28, v10
  v_sub_u32 v11, v152, v11
  v_lshlrev_b32 v10, 17, v10
  v_lshl_add_u32 v10, v11, 4, v10
  v_lshl_add_u32 v153, v6, 9, v10
  v_mul_u32_u24 v10, 7168, v6
  v_lshl_add_u32 v154, v152, 4, v10
  v_lshl_add_u32 v155, v6, 7, v154
  v_lshlrev_b32 v159, 2, v6
  buffer_load_dwordx2 v[156:157], v9, s[44:47], 0 offen sc1
  s_cmp_eq_u32 s28, 0
  s_cbranch_scc0 L_PB
  s_mov_b32 s34, 1049335798
  s_lshl_b32 s35, s41, 15
  s_lshl_b32 s37, s42, 11
  s_add_u32 s35, s35, s37
  s_add_u32 s35, s35, 2097152
  s_lshl_b32 s37, s41, 11
  s_add_u32 s37, s37, 4194304
  s_lshl_b32 s38, s42, 6
  s_add_u32 s38, s38, s41
  s_lshl_b32 s38, s38, 2
  s_add_u32 s38, s38, 16908288
  s_barrier
  ds_read_b64_tr_b16 v[120:121], v164 offset:0
  ds_read_b64_tr_b16 v[122:123], v164 offset:512
  ds_read_b128 v[112:115], v160 offset:0
  ds_read_b128 v[116:119], v160 offset:4096
  ds_read_b64_tr_b16 v[132:133], v164 offset:2048
  ds_read_b64_tr_b16 v[134:135], v164 offset:2560
  ds_read_b128 v[124:127], v161 offset:0
  ds_read_b128 v[128:131], v161 offset:4096
  s_waitcnt lgkmcnt(4)
  v_mfma_f32_32x32x16_bf16 v[48:63], v[120:123], v[112:115], v[48:63]
  ds_read_b64_tr_b16 v[144:145], v164 offset:4096
  ds_read_b64_tr_b16 v[146:147], v164 offset:4608
  v_mfma_f32_32x32x16_bf16 v[64:79], v[120:123], v[116:119], v[64:79]
  ds_read_b128 v[136:139], v162 offset:0
  ds_read_b128 v[140:143], v162 offset:4096
  s_waitcnt lgkmcnt(4)
  v_mfma_f32_32x32x16_bf16 v[48:63], v[132:135], v[124:127], v[48:63]
  ds_read_b64_tr_b16 v[120:121], v164 offset:6144
  ds_read_b64_tr_b16 v[122:123], v164 offset:6656
  v_mfma_f32_32x32x16_bf16 v[64:79], v[132:135], v[128:131], v[64:79]
  ds_read_b128 v[112:115], v163 offset:0
  ds_read_b128 v[116:119], v163 offset:4096
  s_waitcnt lgkmcnt(0)
  s_barrier
  v_mfma_f32_32x32x16_bf16 v[48:63], v[144:147], v[136:139], v[48:63]
  ds_read_b64_tr_b16 v[132:133], v164 offset:8192
  ds_read_b64_tr_b16 v[134:135], v164 offset:8704
  v_mfma_f32_32x32x16_bf16 v[64:79], v[144:147], v[140:143], v[64:79]
  ds_read_b128 v[124:127], v160 offset:16384
  ds_read_b128 v[128:131], v160 offset:20480
  s_waitcnt lgkmcnt(4)
  v_mfma_f32_32x32x16_bf16 v[48:63], v[120:123], v[112:115], v[48:63]
  ds_read_b64_tr_b16 v[144:145], v164 offset:10240
  ds_read_b64_tr_b16 v[146:147], v164 offset:10752
  v_mfma_f32_32x32x16_bf16 v[64:79], v[120:123], v[116:119], v[64:79]
  ds_read_b128 v[136:139], v161 offset:16384
  ds_read_b128 v[140:143], v161 offset:20480
  s_waitcnt lgkmcnt(4)
  v_mfma_f32_32x32x16_bf16 v[48:63], v[132:135], v[124:127], v[48:63]
  ds_read_b64_tr_b16 v[120:121], v164 offset:12288
  ds_read_b64_tr_b16 v[122:123], v164 offset:12800
  v_mfma_f32_32x32x16_bf16 v[64:79], v[132:135], v[128:131], v[64:79]
  ds_read_b128 v[112:115], v162 offset:16384
  ds_read_b128 v[116:119], v162 offset:20480
  s_waitcnt lgkmcnt(4)
  v_mfma_f32_32x32x16_bf16 v[48:63], v[144:147], v[136:139], v[48:63]
  ds_read_b64_tr_b16 v[132:133], v164 offset:14336
  ds_read_b64_tr_b16 v[134:135], v164 offset:14848
  v_mfma_f32_32x32x16_bf16 v[64:79], v[144:147], v[140:143], v[64:79]
  ds_read_b128 v[124:127], v163 offset:16384
  ds_read_b128 v[128:131], v163 offset:20480
  s_waitcnt lgkmcnt(0)
  s_barrier
  v_mfma_f32_32x32x16_bf16 v[48:63], v[120:123], v[112:115], v[48:63]
  ds_read_b64_tr_b16 v[144:145], v164 offset:16384
  ds_read_b64_tr_b16 v[146:147], v164 offset:16896
  v_mfma_f32_32x32x16_bf16 v[64:79], v[120:123], v[116:119], v[64:79]
  ds_read_b128 v[136:139], v160 offset:32768
  ds_read_b128 v[140:143], v160 offset:36864
  s_waitcnt lgkmcnt(4)
  v_mfma_f32_32x32x16_bf16 v[48:63], v[132:135], v[124:127], v[48:63]
  ds_read_b64_tr_b16 v[120:121], v164 offset:18432
  ds_read_b64_tr_b16 v[122:123], v164 offset:18944
  v_mfma_f32_32x32x16_bf16 v[64:79], v[132:135], v[128:131], v[64:79]
  ds_read_b128 v[112:115], v161 offset:32768
  ds_read_b128 v[116:119], v161 offset:36864
  s_waitcnt lgkmcnt(4)
  v_mfma_f32_32x32x16_bf16 v[48:63], v[144:147], v[136:139], v[48:63]
  ds_read_b64_tr_b16 v[132:133], v164 offset:20480
  ds_read_b64_tr_b16 v[134:135], v164 offset:20992
  v_mfma_f32_32x32x16_bf16 v[64:79], v[144:147], v[140:143], v[64:79]
  ds_read_b128 v[124:127], v162 offset:32768
  ds_read_b128 v[128:131], v162 offset:36864
  s_waitcnt lgkmcnt(4)
  v_mfma_f32_32x32x16_bf16 v[48:63], v[120:123], v[112:115], v[48:63]
  ds_read_b64_tr_b16 v[144:145], v164 offset:22528
  ds_read_b64_tr_b16 v[146:147], v164 offset:23040
  v_mfma_f32_32x32x16_bf16 v[64:79], v[120:123], v[116:119], v[64:79]
  ds_read_b128 v[136:139], v163 offset:32768
  ds_read_b128 v[140:143], v163 offset:36864
  s_waitcnt lgkmcnt(0)
  s_barrier
  v_mfma_f32_32x32x16_bf16 v[48:63], v[132:135], v[124:127], v[48:63]
  ds_read_b64_tr_b16 v[120:121], v164 offset:24576
  ds_read_b64_tr_b16 v[122:123], v164 offset:25088
  v_mfma_f32_32x32x16_bf16 v[64:79], v[132:135], v[128:131], v[64:79]
  ds_read_b128 v[112:115], v160 offset:49152
  ds_read_b128 v[116:119], v160 offset:53248
  s_waitcnt lgkmcnt(4)
  v_mfma_f32_32x32x16_bf16 v[48:63], v[144:147], v[136:139], v[48:63]
  ds_read_b64_tr_b16 v[132:133], v164 offset:26624
  ds_read_b64_tr_b16 v[134:135], v164 offset:27136
  v_mfma_f32_32x32x16_bf16 v[64:79], v[144:147], v[140:143], v[64:79]
  ds_read_b128 v[124:127], v161 offset:49152
  ds_read_b128 v[128:131], v161 offset:53248
  s_waitcnt lgkmcnt(4)
  v_mfma_f32_32x32x16_bf16 v[48:63], v[120:123], v[112:115], v[48:63]
  ds_read_b64_tr_b16 v[144:145], v164 offset:28672
  ds_read_b64_tr_b16 v[146:147], v164 offset:29184
  v_mfma_f32_32x32x16_bf16 v[64:79], v[120:123], v[116:119], v[64:79]
  ds_read_b128 v[136:139], v162 offset:49152
  ds_read_b128 v[140:143], v162 offset:53248
  s_waitcnt lgkmcnt(4)
  v_mfma_f32_32x32x16_bf16 v[48:63], v[132:135], v[124:127], v[48:63]
  ds_read_b64_tr_b16 v[120:121], v164 offset:30720
  ds_read_b64_tr_b16 v[122:123], v164 offset:31232
  v_mfma_f32_32x32x16_bf16 v[64:79], v[132:135], v[128:131], v[64:79]
  ds_read_b128 v[112:115], v163 offset:49152
  ds_read_b128 v[116:119], v163 offset:53248
  s_waitcnt lgkmcnt(0)
  s_barrier
  v_mfma_f32_32x32x16_bf16 v[48:63], v[144:147], v[136:139], v[48:63]
  ds_read_b64_tr_b16 v[132:133], v164 offset:32768
  ds_read_b64_tr_b16 v[134:135], v164 offset:33280
  v_mfma_f32_32x32x16_bf16 v[64:79], v[144:147], v[140:143], v[64:79]
  ds_read_b128 v[124:127], v165 offset:0
  ds_read_b128 v[128:131], v165 offset:4096
  s_waitcnt lgkmcnt(4)
  v_mfma_f32_32x32x16_bf16 v[48:63], v[120:123], v[112:115], v[48:63]
  ds_read_b64_tr_b16 v[144:145], v164 offset:34816
  ds_read_b64_tr_b16 v[146:147], v164 offset:35328
  v_mfma_f32_32x32x16_bf16 v[64:79], v[120:123], v[116:119], v[64:79]
  ds_read_b128 v[136:139], v166 offset:0
  ds_read_b128 v[140:143], v166 offset:4096
  s_waitcnt lgkmcnt(4)
  v_mfma_f32_32x32x16_bf16 v[48:63], v[132:135], v[124:127], v[48:63]
  ds_read_b64_tr_b16 v[120:121], v164 offset:36864
  ds_read_b64_tr_b16 v[122:123], v164 offset:37376
  v_mfma_f32_32x32x16_bf16 v[64:79], v[132:135], v[128:131], v[64:79]
  ds_read_b128 v[112:115], v167 offset:0
  ds_read_b128 v[116:119], v167 offset:4096
  s_waitcnt lgkmcnt(4)
  v_mfma_f32_32x32x16_bf16 v[48:63], v[144:147], v[136:139], v[48:63]
  ds_read_b64_tr_b16 v[132:133], v164 offset:38912
  ds_read_b64_tr_b16 v[134:135], v164 offset:39424
  v_mfma_f32_32x32x16_bf16 v[64:79], v[144:147], v[140:143], v[64:79]
  ds_read_b128 v[124:127], v168 offset:0
  ds_read_b128 v[128:131], v168 offset:4096
  s_waitcnt lgkmcnt(0)
  s_barrier
  v_mfma_f32_32x32x16_bf16 v[48:63], v[120:123], v[112:115], v[48:63]
  ds_read_b64_tr_b16 v[144:145], v164 offset:40960
  ds_read_b64_tr_b16 v[146:147], v164 offset:41472
  v_mfma_f32_32x32x16_bf16 v[64:79], v[120:123], v[116:119], v[64:79]
  ds_read_b128 v[136:139], v165 offset:16384
  ds_read_b128 v[140:143], v165 offset:20480
  s_waitcnt lgkmcnt(4)
  v_mfma_f32_32x32x16_bf16 v[48:63], v[132:135], v[124:127], v[48:63]
  ds_read_b64_tr_b16 v[120:121], v164 offset:43008
  ds_read_b64_tr_b16 v[122:123], v164 offset:43520
  v_mfma_f32_32x32x16_bf16 v[64:79], v[132:135], v[128:131], v[64:79]
  ds_read_b128 v[112:115], v166 offset:16384
  ds_read_b128 v[116:119], v166 offset:20480
  s_waitcnt lgkmcnt(4)
  v_mfma_f32_32x32x16_bf16 v[48:63], v[144:147], v[136:139], v[48:63]
  ds_read_b64_tr_b16 v[132:133], v164 offset:45056
  ds_read_b64_tr_b16 v[134:135], v164 offset:45568
  v_mfma_f32_32x32x16_bf16 v[64:79], v[144:147], v[140:143], v[64:79]
  ds_read_b128 v[124:127], v167 offset:16384
  ds_read_b128 v[128:131], v167 offset:20480
  s_waitcnt lgkmcnt(4)
  v_mfma_f32_32x32x16_bf16 v[48:63], v[120:123], v[112:115], v[48:63]
  ds_read_b64_tr_b16 v[144:145], v164 offset:47104
  ds_read_b64_tr_b16 v[146:147], v164 offset:47616
  v_mfma_f32_32x32x16_bf16 v[64:79], v[120:123], v[116:119], v[64:79]
  ds_read_b128 v[136:139], v168 offset:16384
  ds_read_b128 v[140:143], v168 offset:20480
  s_waitcnt lgkmcnt(0)
  s_barrier
  v_mfma_f32_32x32x16_bf16 v[48:63], v[132:135], v[124:127], v[48:63]
  ds_read_b64_tr_b16 v[120:121], v164 offset:0
  ds_read_b64_tr_b16 v[122:123], v164 offset:512
  v_mfma_f32_32x32x16_bf16 v[64:79], v[132:135], v[128:131], v[64:79]
  ds_read_b128 v[112:115], v165 offset:32768
  ds_read_b128 v[116:119], v165 offset:36864
  s_waitcnt lgkmcnt(4)
  v_mfma_f32_32x32x16_bf16 v[48:63], v[144:147], v[136:139], v[48:63]
  ds_read_b64_tr_b16 v[132:133], v164 offset:2048
  ds_read_b64_tr_b16 v[134:135], v164 offset:2560
  v_mfma_f32_32x32x16_bf16 v[64:79], v[144:147], v[140:143], v[64:79]
  ds_read_b128 v[124:127], v166 offset:32768
  ds_read_b128 v[128:131], v166 offset:36864
  s_waitcnt lgkmcnt(4)
  v_mfma_f32_32x32x16_bf16 v[48:63], v[120:123], v[112:115], v[48:63]
  ds_read_b64_tr_b16 v[144:145], v164 offset:4096
  ds_read_b64_tr_b16 v[146:147], v164 offset:4608
  v_mfma_f32_32x32x16_bf16 v[64:79], v[120:123], v[116:119], v[64:79]
  ds_read_b128 v[136:139], v167 offset:32768
  ds_read_b128 v[140:143], v167 offset:36864
  s_waitcnt lgkmcnt(4)
  v_mfma_f32_32x32x16_bf16 v[48:63], v[132:135], v[124:127], v[48:63]
  ds_read_b64_tr_b16 v[120:121], v164 offset:6144
  ds_read_b64_tr_b16 v[122:123], v164 offset:6656
  v_mfma_f32_32x32x16_bf16 v[64:79], v[132:135], v[128:131], v[64:79]
  ds_read_b128 v[112:115], v168 offset:32768
  ds_read_b128 v[116:119], v168 offset:36864
  s_waitcnt lgkmcnt(0)
  s_barrier
  v_mfma_f32_32x32x16_bf16 v[48:63], v[144:147], v[136:139], v[48:63]
  ds_read_b64_tr_b16 v[132:133], v164 offset:8192
  ds_read_b64_tr_b16 v[134:135], v164 offset:8704
  v_mfma_f32_32x32x16_bf16 v[64:79], v[144:147], v[140:143], v[64:79]
  ds_read_b128 v[124:127], v160 offset:0
  ds_read_b128 v[128:131], v160 offset:4096
  s_waitcnt lgkmcnt(4)
  v_mfma_f32_32x32x16_bf16 v[48:63], v[120:123], v[112:115], v[48:63]
  ds_read_b64_tr_b16 v[144:145], v164 offset:10240
  ds_read_b64_tr_b16 v[146:147], v164 offset:10752
  v_mfma_f32_32x32x16_bf16 v[64:79], v[120:123], v[116:119], v[64:79]
  ds_read_b128 v[136:139], v161 offset:0
  ds_read_b128 v[140:143], v161 offset:4096
  s_waitcnt lgkmcnt(4)
  v_mfma_f32_32x32x16_bf16 v[80:95], v[124:127], v[132:135], 0
  ds_read_b64_tr_b16 v[120:121], v164 offset:12288
  ds_read_b64_tr_b16 v[122:123], v164 offset:12800
  v_mfma_f32_32x32x16_bf16 v[96:111], v[128:131], v[132:135], 0
  ds_read_b128 v[112:115], v162 offset:0
  ds_read_b128 v[116:119], v162 offset:4096
  s_waitcnt lgkmcnt(4)
  v_mfma_f32_32x32x16_bf16 v[80:95], v[136:139], v[144:147], v[80:95]
  ds_read_b64_tr_b16 v[132:133], v164 offset:14336
  ds_read_b64_tr_b16 v[134:135], v164 offset:14848
  v_mfma_f32_32x32x16_bf16 v[96:111], v[140:143], v[144:147], v[96:111]
  ds_read_b128 v[124:127], v163 offset:0
  ds_read_b128 v[128:131], v163 offset:4096
  s_waitcnt lgkmcnt(4)
  v_mfma_f32_32x32x16_bf16 v[80:95], v[112:115], v[120:123], v[80:95]
  ds_read_b64_tr_b16 v[144:145], v164 offset:16384
  ds_read_b64_tr_b16 v[146:147], v164 offset:16896
  v_cvt_pk_bf16_f32 v176, v48, v49
  v_cvt_pk_bf16_f32 v177, v50, v51
  v_mfma_f32_32x32x16_bf16 v[96:111], v[116:119], v[120:123], v[96:111]
  ds_read_b128 v[136:139], v160 offset:16384
  ds_read_b128 v[140:143], v160 offset:20480
  v_cvt_pk_bf16_f32 v178, v52, v53
  v_cvt_pk_bf16_f32 v179, v54, v55
  s_waitcnt lgkmcnt(4)
  v_mfma_f32_32x32x16_bf16 v[80:95], v[124:127], v[132:135], v[80:95]
  ds_read_b64_tr_b16 v[120:121], v164 offset:18432
  ds_read_b64_tr_b16 v[122:123], v164 offset:18944
  v_cvt_pk_bf16_f32 v180, v56, v57
  v_cvt_pk_bf16_f32 v181, v58, v59
  v_mfma_f32_32x32x16_bf16 v[96:111], v[128:131], v[132:135], v[96:111]
  ds_read_b128 v[112:115], v161 offset:16384
  ds_read_b128 v[116:119], v161 offset:20480
  v_cvt_pk_bf16_f32 v182, v60, v61
  v_cvt_pk_bf16_f32 v183, v62, v63
  s_waitcnt lgkmcnt(4)
  v_mfma_f32_32x32x16_bf16 v[80:95], v[136:139], v[144:147], v[80:95]
  ds_read_b64_tr_b16 v[132:133], v164 offset:20480
  ds_read_b64_tr_b16 v[134:135], v164 offset:20992
  v_mul_f32 v170, v48, v48
  v_fmac_f32 v170, v49, v49
  v_mfma_f32_32x32x16_bf16 v[96:111], v[140:143], v[144:147], v[96:111]
  ds_read_b128 v[124:127], v162 offset:16384
  ds_read_b128 v[128:131], v162 offset:20480
  v_permlane32_swap_b32 v176, v178
  v_permlane32_swap_b32 v177, v179
  s_waitcnt lgkmcnt(4)
  v_mfma_f32_32x32x16_bf16 v[80:95], v[112:115], v[120:123], v[80:95]
  ds_read_b64_tr_b16 v[144:145], v164 offset:22528
  ds_read_b64_tr_b16 v[146:147], v164 offset:23040
  v_permlane32_swap_b32 v180, v182
  v_permlane32_swap_b32 v181, v183
  v_mfma_f32_32x32x16_bf16 v[96:111], v[116:119], v[120:123], v[96:111]
  ds_read_b128 v[136:139], v163 offset:16384
  ds_read_b128 v[140:143], v163 offset:20480
  buffer_store_dwordx4 v[176:179], v8, s[24:27], s35 offen offset:0 sc1
  buffer_store_dwordx4 v[180:183], v8, s[24:27], s35 offen offset:1024 sc1
  s_add_u32 s35, s35, 32768
  s_waitcnt lgkmcnt(0)
  s_barrier
  v_mfma_f32_32x32x16_bf16 v[80:95], v[124:127], v[132:135], v[80:95]
  ds_read_b64_tr_b16 v[120:121], v164 offset:24576
  ds_read_b64_tr_b16 v[122:123], v164 offset:25088
  v_cvt_pk_bf16_f32 v184, v64, v65
  v_cvt_pk_bf16_f32 v185, v66, v67
  v_mfma_f32_32x32x16_bf16 v[96:111], v[128:131], v[132:135], v[96:111]
  ds_read_b128 v[112:115], v160 offset:32768
  ds_read_b128 v[116:119], v160 offset:36864
  v_cvt_pk_bf16_f32 v186, v68, v69
  v_cvt_pk_bf16_f32 v187, v70, v71
  s_waitcnt lgkmcnt(4)
  v_mfma_f32_32x32x16_bf16 v[80:95], v[136:139], v[144:147], v[80:95]
  ds_read_b64_tr_b16 v[132:133], v164 offset:26624
  ds_read_b64_tr_b16 v[134:135], v164 offset:27136
  v_cvt_pk_bf16_f32 v188, v72, v73
  v_cvt_pk_bf16_f32 v189, v74, v75
  v_mfma_f32_32x32x16_bf16 v[96:111], v[140:143], v[144:147], v[96:111]
  ds_read_b128 v[124:127], v161 offset:32768
  ds_read_b128 v[128:131], v161 offset:36864
  v_cvt_pk_bf16_f32 v190, v76, v77
  v_cvt_pk_bf16_f32 v191, v78, v79
  s_waitcnt lgkmcnt(4)
  v_mfma_f32_32x32x16_bf16 v[80:95], v[112:115], v[120:123], v[80:95]
  ds_read_b64_tr_b16 v[144:145], v164 offset:28672
  ds_read_b64_tr_b16 v[146:147], v164 offset:29184
  v_mul_f32 v171, v64, v64
  v_fmac_f32 v171, v65, v65
  v_mfma_f32_32x32x16_bf16 v[96:111], v[116:119], v[120:123], v[96:111]
  ds_read_b128 v[136:139], v162 offset:32768
  ds_read_b128 v[140:143], v162 offset:36864
  v_permlane32_swap_b32 v184, v186
  v_permlane32_swap_b32 v185, v187
  s_waitcnt lgkmcnt(4)
  v_mfma_f32_32x32x16_bf16 v[80:95], v[124:127], v[132:135], v[80:95]
  ds_read_b64_tr_b16 v[120:121], v164 offset:30720
  ds_read_b64_tr_b16 v[122:123], v164 offset:31232
  v_permlane32_swap_b32 v188, v190
  v_permlane32_swap_b32 v189, v191
  v_mfma_f32_32x32x16_bf16 v[96:111], v[128:131], v[132:135], v[96:111]
  ds_read_b128 v[112:115], v163 offset:32768
  ds_read_b128 v[116:119], v163 offset:36864
  buffer_store_dwordx4 v[184:187], v8, s[24:27], s35 offen offset:0 sc1
  buffer_store_dwordx4 v[188:191], v8, s[24:27], s35 offen offset:1024 sc1
  s_add_u32 s35, s35, 4292837376
  s_waitcnt lgkmcnt(4)
  v_mfma_f32_32x32x16_bf16 v[80:95], v[136:139], v[144:147], v[80:95]
  ds_read_b64_tr_b16 v[132:133], v164 offset:32768
  ds_read_b64_tr_b16 v[134:135], v164 offset:33280
  v_fmac_f32 v170, v50, v50
  v_fmac_f32 v171, v66, v66
  v_mfma_f32_32x32x16_bf16 v[96:111], v[140:143], v[144:147], v[96:111]
  ds_read_b128 v[124:127], v160 offset:49152
  ds_read_b128 v[128:131], v160 offset:53248
  v_fmac_f32 v170, v51, v51
  v_fmac_f32 v171, v67, v67
  s_waitcnt lgkmcnt(4)
  v_mfma_f32_32x32x16_bf16 v[80:95], v[112:115], v[120:123], v[80:95]
  ds_read_b64_tr_b16 v[144:145], v164 offset:34816
  ds_read_b64_tr_b16 v[146:147], v164 offset:35328
  v_fmac_f32 v170, v52, v52
  v_fmac_f32 v171, v68, v68
  v_mfma_f32_32x32x16_bf16 v[96:111], v[116:119], v[120:123], v[96:111]
  ds_read_b128 v[136:139], v161 offset:49152
  ds_read_b128 v[140:143], v161 offset:53248
  v_fmac_f32 v170, v53, v53
  v_fmac_f32 v171, v69, v69
  s_waitcnt lgkmcnt(4)
  v_mfma_f32_32x32x16_bf16 v[80:95], v[124:127], v[132:135], v[80:95]
  ds_read_b64_tr_b16 v[120:121], v164 offset:36864
  ds_read_b64_tr_b16 v[122:123], v164 offset:37376
  v_fmac_f32 v170, v54, v54
  v_fmac_f32 v171, v70, v70
  v_mfma_f32_32x32x16_bf16 v[96:111], v[128:131], v[132:135], v[96:111]
  ds_read_b128 v[112:115], v162 offset:49152
  ds_read_b128 v[116:119], v162 offset:53248
  v_fmac_f32 v170, v55, v55
  v_fmac_f32 v171, v71, v71
  s_waitcnt lgkmcnt(4)
  v_mfma_f32_32x32x16_bf16 v[80:95], v[136:139], v[144:147], v[80:95]
  ds_read_b64_tr_b16 v[132:133], v164 offset:38912
  ds_read_b64_tr_b16 v[134:135], v164 offset:39424
  v_fmac_f32 v170, v56, v56
  v_fmac_f32 v171, v72, v72
  v_mfma_f32_32x32x16_bf16 v[96:111], v[140:143], v[144:147], v[96:111]
  ds_read_b128 v[124:127], v163 offset:49152
  ds_read_b128 v[128:131], v163 offset:53248
  v_fmac_f32 v170, v57, v57
  v_fmac_f32 v171, v73, v73
  s_waitcnt lgkmcnt(0)
  s_barrier
  v_mfma_f32_32x32x16_bf16 v[80:95], v[112:115], v[120:123], v[80:95]
  ds_read_b64_tr_b16 v[144:145], v164 offset:40960
  ds_read_b64_tr_b16 v[146:147], v164 offset:41472
  v_fmac_f32 v170, v58, v58
  v_fmac_f32 v171, v74, v74
  v_mfma_f32_32x32x16_bf16 v[96:111], v[116:119], v[120:123], v[96:111]
  ds_read_b128 v[136:139], v165 offset:0
  ds_read_b128 v[140:143], v165 offset:4096
  v_fmac_f32 v170, v59, v59
  v_fmac_f32 v171, v75, v75
  s_waitcnt lgkmcnt(4)
  v_mfma_f32_32x32x16_bf16 v[80:95], v[124:127], v[132:135], v[80:95]
  ds_read_b64_tr_b16 v[120:121], v164 offset:43008
  ds_read_b64_tr_b16 v[122:123], v164 offset:43520
  v_fmac_f32 v170, v60, v60
  v_fmac_f32 v171, v76, v76
  v_mfma_f32_32x32x16_bf16 v[96:111], v[128:131], v[132:135], v[96:111]
  ds_read_b128 v[112:115], v166 offset:0
  ds_read_b128 v[116:119], v166 offset:4096
  v_fmac_f32 v170, v61, v61
  v_fmac_f32 v171, v77, v77
  s_waitcnt lgkmcnt(4)
  v_mfma_f32_32x32x16_bf16 v[80:95], v[136:139], v[144:147], v[80:95]
  ds_read_b64_tr_b16 v[132:133], v164 offset:45056
  ds_read_b64_tr_b16 v[134:135], v164 offset:45568
  v_fmac_f32 v170, v62, v62
  v_fmac_f32 v171, v78, v78
  v_mfma_f32_32x32x16_bf16 v[96:111], v[140:143], v[144:147], v[96:111]
  ds_read_b128 v[124:127], v167 offset:0
  ds_read_b128 v[128:131], v167 offset:4096
  v_fmac_f32 v170, v63, v63
  v_fmac_f32 v171, v79, v79
  s_waitcnt lgkmcnt(4)
  v_mfma_f32_32x32x16_bf16 v[80:95], v[112:115], v[120:123], v[80:95]
  ds_read_b64_tr_b16 v[144:145], v164 offset:47104
  ds_read_b64_tr_b16 v[146:147], v164 offset:47616
  s_nop 1
  v_permlane32_swap_b32 v170, v171
  v_add_f32 v170, v170, v171
  s_nop 1
  v_max_f32_dpp v170, v170, v170 quad_perm:[1,0,3,2] row_mask:0xf bank_mask:0xf
  v_mfma_f32_32x32x16_bf16 v[96:111], v[116:119], v[120:123], v[96:111]
  ds_read_b128 v[136:139], v168 offset:0
  ds_read_b128 v[140:143], v168 offset:4096
  s_nop 1
  v_max_f32_dpp v170, v170, v170 quad_perm:[2,3,0,1] row_mask:0xf bank_mask:0xf
  s_nop 1
  v_max_f32_dpp v170, v170, v170 row_half_mirror row_mask:0xf bank_mask:0xf
  s_waitcnt lgkmcnt(4)
  v_mfma_f32_32x32x16_bf16 v[80:95], v[124:127], v[132:135], v[80:95]
  ds_read_b64_tr_b16 v[120:121], v164 offset:0
  ds_read_b64_tr_b16 v[122:123], v164 offset:512
  s_nop 1
  v_max_f32_dpp v170, v170, v170 row_mirror row_mask:0xf bank_mask:0xf
  s_nop 1
  v_max_f32_dpp v170, v170, v170 row_bcast:15 row_mask:0xa bank_mask:0xf
  v_mfma_f32_32x32x16_bf16 v[96:111], v[128:131], v[132:135], v[96:111]
  ds_read_b128 v[112:115], v165 offset:16384
  ds_read_b128 v[116:119], v165 offset:20480
  s_mov_b32 exec_lo, 0x80000000
  s_mov_b32 exec_hi, 0x80000000
  buffer_store_dword v170, v159, s[24:27], s38 offen offset:3584 sc1
  s_mov_b64 exec, -1
  s_waitcnt lgkmcnt(4)
  v_mfma_f32_32x32x16_bf16 v[80:95], v[136:139], v[144:147], v[80:95]
  ds_read_b64_tr_b16 v[132:133], v164 offset:2048
  ds_read_b64_tr_b16 v[134:135], v164 offset:2560
  v_mfma_f32_32x32x16_bf16 v[96:111], v[140:143], v[144:147], v[96:111]
  ds_read_b128 v[124:127], v166 offset:16384
  ds_read_b128 v[128:131], v166 offset:20480
  s_waitcnt lgkmcnt(4)
  v_mfma_f32_32x32x16_bf16 v[80:95], v[112:115], v[120:123], v[80:95]
  ds_read_b64_tr_b16 v[144:145], v164 offset:4096
  ds_read_b64_tr_b16 v[146:147], v164 offset:4608
  v_mfma_f32_32x32x16_bf16 v[96:111], v[116:119], v[120:123], v[96:111]
  ds_read_b128 v[136:139], v167 offset:16384
  ds_read_b128 v[140:143], v167 offset:20480
  s_waitcnt lgkmcnt(4)
  v_mfma_f32_32x32x16_bf16 v[80:95], v[124:127], v[132:135], v[80:95]
  ds_read_b64_tr_b16 v[120:121], v164 offset:6144
  ds_read_b64_tr_b16 v[122:123], v164 offset:6656
  v_mfma_f32_32x32x16_bf16 v[96:111], v[128:131], v[132:135], v[96:111]
  ds_read_b128 v[112:115], v168 offset:16384
  ds_read_b128 v[116:119], v168 offset:20480
  s_waitcnt lgkmcnt(0)
  s_barrier
  v_mfma_f32_32x32x16_bf16 v[80:95], v[136:139], v[144:147], v[80:95]
  ds_read_b64_tr_b16 v[132:133], v164 offset:8192
  ds_read_b64_tr_b16 v[134:135], v164 offset:8704
  v_mfma_f32_32x32x16_bf16 v[96:111], v[140:143], v[144:147], v[96:111]
  ds_read_b128 v[124:127], v165 offset:32768
  ds_read_b128 v[128:131], v165 offset:36864
  s_waitcnt lgkmcnt(4)
  v_mfma_f32_32x32x16_bf16 v[80:95], v[112:115], v[120:123], v[80:95]
  ds_read_b64_tr_b16 v[144:145], v164 offset:10240
  ds_read_b64_tr_b16 v[146:147], v164 offset:10752
  v_mfma_f32_32x32x16_bf16 v[96:111], v[116:119], v[120:123], v[96:111]
  ds_read_b128 v[136:139], v166 offset:32768
  ds_read_b128 v[140:143], v166 offset:36864
  s_waitcnt lgkmcnt(4)
  v_mfma_f32_32x32x16_bf16 v[80:95], v[124:127], v[132:135], v[80:95]
  ds_read_b64_tr_b16 v[120:121], v164 offset:12288
  ds_read_b64_tr_b16 v[122:123], v164 offset:12800
  v_mfma_f32_32x32x16_bf16 v[96:111], v[128:131], v[132:135], v[96:111]
  ds_read_b128 v[112:115], v167 offset:32768
  ds_read_b128 v[116:119], v167 offset:36864
  s_waitcnt lgkmcnt(4)
  v_mfma_f32_32x32x16_bf16 v[80:95], v[136:139], v[144:147], v[80:95]
  ds_read_b64_tr_b16 v[132:133], v164 offset:14336
  ds_read_b64_tr_b16 v[134:135], v164 offset:14848
  v_mfma_f32_32x32x16_bf16 v[96:111], v[140:143], v[144:147], v[96:111]
  ds_read_b128 v[124:127], v168 offset:32768
  ds_read_b128 v[128:131], v168 offset:36864
  s_waitcnt lgkmcnt(4)
  v_mfma_f32_32x32x16_bf16 v[80:95], v[112:115], v[120:123], v[80:95]
  ds_read_b64_tr_b16 v[144:145], v164 offset:16384
  ds_read_b64_tr_b16 v[146:147], v164 offset:16896
  v_mfma_f32_32x32x16_bf16 v[96:111], v[116:119], v[120:123], v[96:111]
  ds_read_b128 v[136:139], v160 offset:0
  ds_read_b128 v[140:143], v160 offset:4096
  s_waitcnt lgkmcnt(4)
  v_mfma_f32_32x32x16_bf16 v[80:95], v[124:127], v[132:135], v[80:95]
  ds_read_b64_tr_b16 v[120:121], v164 offset:18432
  ds_read_b64_tr_b16 v[122:123], v164 offset:18944
  v_mfma_f32_32x32x16_bf16 v[96:111], v[128:131], v[132:135], v[96:111]
  ds_read_b128 v[112:115], v161 offset:0
  ds_read_b128 v[116:119], v161 offset:4096
  s_waitcnt lgkmcnt(4)
  v_mfma_f32_32x32x16_bf16 v[16:31], v[144:147], v[136:139], v[16:31]
  ds_read_b64_tr_b16 v[132:133], v164 offset:20480
  ds_read_b64_tr_b16 v[134:135], v164 offset:20992
  v_mfma_f32_32x32x16_bf16 v[32:47], v[144:147], v[140:143], v[32:47]
  ds_read_b128 v[124:127], v162 offset:0
  ds_read_b128 v[128:131], v162 offset:4096
  s_waitcnt lgkmcnt(4)
  v_mfma_f32_32x32x16_bf16 v[16:31], v[120:123], v[112:115], v[16:31]
  ds_read_b64_tr_b16 v[144:145], v164 offset:22528
  ds_read_b64_tr_b16 v[146:147], v164 offset:23040
  v_mfma_f32_32x32x16_bf16 v[32:47], v[120:123], v[116:119], v[32:47]
  ds_read_b128 v[136:139], v163 offset:0
  ds_read_b128 v[140:143], v163 offset:4096
  s_waitcnt lgkmcnt(0)
  s_barrier
  v_mfma_f32_32x32x16_bf16 v[16:31], v[132:135], v[124:127], v[16:31]
  ds_read_b64_tr_b16 v[120:121], v164 offset:24576
  ds_read_b64_tr_b16 v[122:123], v164 offset:25088
  v_cvt_pk_bf16_f32 v192, v80, v81
  v_cvt_pk_bf16_f32 v193, v82, v83
  v_mfma_f32_32x32x16_bf16 v[32:47], v[132:135], v[128:131], v[32:47]
  ds_read_b128 v[112:115], v160 offset:16384
  ds_read_b128 v[116:119], v160 offset:20480
  v_cvt_pk_bf16_f32 v194, v84, v85
  v_cvt_pk_bf16_f32 v195, v86, v87
  s_waitcnt lgkmcnt(4)
  v_mfma_f32_32x32x16_bf16 v[16:31], v[144:147], v[136:139], v[16:31]
  ds_read_b64_tr_b16 v[132:133], v164 offset:26624
  ds_read_b64_tr_b16 v[134:135], v164 offset:27136
  v_cvt_pk_bf16_f32 v196, v88, v89
  v_cvt_pk_bf16_f32 v197, v90, v91
  v_mfma_f32_32x32x16_bf16 v[32:47], v[144:147], v[140:143], v[32:47]
  ds_read_b128 v[124:127], v161 offset:16384
  ds_read_b128 v[128:131], v161 offset:20480
  v_cvt_pk_bf16_f32 v198, v92, v93
  v_cvt_pk_bf16_f32 v199, v94, v95
  s_waitcnt lgkmcnt(4)
  v_mfma_f32_32x32x16_bf16 v[16:31], v[120:123], v[112:115], v[16:31]
  ds_read_b64_tr_b16 v[144:145], v164 offset:28672
  ds_read_b64_tr_b16 v[146:147], v164 offset:29184
  buffer_store_dwordx4 v[192:195], v153, s[24:27], s37 offen offset:0 sc1
  buffer_store_dwordx4 v[196:199], v153, s[24:27], s37 offen offset:1024 sc1
  v_mfma_f32_32x32x16_bf16 v[32:47], v[120:123], v[116:119], v[32:47]
  ds_read_b128 v[136:139], v162 offset:16384
  ds_read_b128 v[140:143], v162 offset:20480
  v_cvt_pk_bf16_f32 v200, v96, v97
  v_cvt_pk_bf16_f32 v201, v98, v99
  s_waitcnt lgkmcnt(4)
  v_mfma_f32_32x32x16_bf16 v[16:31], v[132:135], v[124:127], v[16:31]
  ds_read_b64_tr_b16 v[120:121], v164 offset:30720
  ds_read_b64_tr_b16 v[122:123], v164 offset:31232
  v_cvt_pk_bf16_f32 v202, v100, v101
  v_cvt_pk_bf16_f32 v203, v102, v103
  v_mfma_f32_32x32x16_bf16 v[32:47], v[132:135], v[128:131], v[32:47]
  ds_read_b128 v[112:115], v163 offset:16384
  ds_read_b128 v[116:119], v163 offset:20480
  v_cvt_pk_bf16_f32 v204, v104, v105
  v_cvt_pk_bf16_f32 v205, v106, v107
  s_waitcnt lgkmcnt(4)
  v_mfma_f32_32x32x16_bf16 v[16:31], v[144:147], v[136:139], v[16:31]
  ds_read_b64_tr_b16 v[132:133], v164 offset:32768
  ds_read_b64_tr_b16 v[134:135], v164 offset:33280
  v_cvt_pk_bf16_f32 v206, v108, v109
  v_cvt_pk_bf16_f32 v207, v110, v111
  v_mfma_f32_32x32x16_bf16 v[32:47], v[144:147], v[140:143], v[32:47]
  ds_read_b128 v[124:127], v160 offset:32768
  ds_read_b128 v[128:131], v160 offset:36864
  buffer_store_dwordx4 v[200:203], v153, s[24:27], s37 offen offset:2048 sc1
  buffer_store_dwordx4 v[204:207], v153, s[24:27], s37 offen offset:3072 sc1
  s_waitcnt lgkmcnt(4)
  v_mfma_f32_32x32x16_bf16 v[16:31], v[120:123], v[112:115], v[16:31]
  ds_read_b64_tr_b16 v[144:145], v164 offset:34816
  ds_read_b64_tr_b16 v[146:147], v164 offset:35328
  v_mfma_f32_32x32x16_bf16 v[32:47], v[120:123], v[116:119], v[32:47]
  ds_read_b128 v[136:139], v161 offset:32768
  ds_read_b128 v[140:143], v161 offset:36864
  s_waitcnt lgkmcnt(4)
  v_mfma_f32_32x32x16_bf16 v[16:31], v[132:135], v[124:127], v[16:31]
  ds_read_b64_tr_b16 v[120:121], v164 offset:36864
  ds_read_b64_tr_b16 v[122:123], v164 offset:37376
  v_mfma_f32_32x32x16_bf16 v[32:47], v[132:135], v[128:131], v[32:47]
  ds_read_b128 v[112:115], v162 offset:32768
  ds_read_b128 v[116:119], v162 offset:36864
  s_waitcnt lgkmcnt(4)
  v_mfma_f32_32x32x16_bf16 v[16:31], v[144:147], v[136:139], v[16:31]
  ds_read_b64_tr_b16 v[132:133], v164 offset:38912
  ds_read_b64_tr_b16 v[134:135], v164 offset:39424
  v_mfma_f32_32x32x16_bf16 v[32:47], v[144:147], v[140:143], v[32:47]
  ds_read_b128 v[124:127], v163 offset:32768
  ds_read_b128 v[128:131], v163 offset:36864
  s_waitcnt lgkmcnt(0)
  s_barrier
  v_mfma_f32_32x32x16_bf16 v[16:31], v[120:123], v[112:115], v[16:31]
  ds_read_b64_tr_b16 v[144:145], v164 offset:40960
  ds_read_b64_tr_b16 v[146:147], v164 offset:41472
  v_mfma_f32_32x32x16_bf16 v[32:47], v[120:123], v[116:119], v[32:47]
  ds_read_b128 v[136:139], v160 offset:49152
  ds_read_b128 v[140:143], v160 offset:53248
  s_waitcnt lgkmcnt(4)
  v_mfma_f32_32x32x16_bf16 v[16:31], v[132:135], v[124:127], v[16:31]
  ds_read_b64_tr_b16 v[120:121], v164 offset:43008
  ds_read_b64_tr_b16 v[122:123], v164 offset:43520
  v_mfma_f32_32x32x16_bf16 v[32:47], v[132:135], v[128:131], v[32:47]
  ds_read_b128 v[112:115], v161 offset:49152
  ds_read_b128 v[116:119], v161 offset:53248
  s_waitcnt lgkmcnt(4)
  v_mfma_f32_32x32x16_bf16 v[16:31], v[144:147], v[136:139], v[16:31]
  ds_read_b64_tr_b16 v[132:133], v164 offset:45056
  ds_read_b64_tr_b16 v[134:135], v164 offset:45568
  v_mfma_f32_32x32x16_bf16 v[32:47], v[144:147], v[140:143], v[32:47]
  ds_read_b128 v[124:127], v162 offset:49152
  ds_read_b128 v[128:131], v162 offset:53248
  s_waitcnt lgkmcnt(4)
  v_mfma_f32_32x32x16_bf16 v[16:31], v[120:123], v[112:115], v[16:31]
  ds_read_b64_tr_b16 v[144:145], v164 offset:47104
  ds_read_b64_tr_b16 v[146:147], v164 offset:47616
  v_mfma_f32_32x32x16_bf16 v[32:47], v[120:123], v[116:119], v[32:47]
  ds_read_b128 v[136:139], v163 offset:49152
  ds_read_b128 v[140:143], v163 offset:53248
  s_waitcnt lgkmcnt(4)
  v_mfma_f32_32x32x16_bf16 v[16:31], v[132:135], v[124:127], v[16:31]
  ds_read_b64_tr_b16 v[120:121], v164 offset:0
  ds_read_b64_tr_b16 v[122:123], v164 offset:512
  v_mfma_f32_32x32x16_bf16 v[32:47], v[132:135], v[128:131], v[32:47]
  ds_read_b128 v[112:115], v165 offset:0
  ds_read_b128 v[116:119], v165 offset:4096
  s_waitcnt lgkmcnt(4)
  v_mfma_f32_32x32x16_bf16 v[16:31], v[144:147], v[136:139], v[16:31]
  ds_read_b64_tr_b16 v[132:133], v164 offset:2048
  ds_read_b64_tr_b16 v[134:135], v164 offset:2560
  v_mfma_f32_32x32x16_bf16 v[32:47], v[144:147], v[140:143], v[32:47]
  ds_read_b128 v[124:127], v166 offset:0
  ds_read_b128 v[128:131], v166 offset:4096
  s_waitcnt lgkmcnt(4)
  v_mfma_f32_32x32x16_bf16 v[16:31], v[120:123], v[112:115], v[16:31]
  ds_read_b64_tr_b16 v[144:145], v164 offset:4096
  ds_read_b64_tr_b16 v[146:147], v164 offset:4608
  v_mfma_f32_32x32x16_bf16 v[32:47], v[120:123], v[116:119], v[32:47]
  ds_read_b128 v[136:139], v167 offset:0
  ds_read_b128 v[140:143], v167 offset:4096
  s_waitcnt lgkmcnt(4)
  v_mfma_f32_32x32x16_bf16 v[16:31], v[132:135], v[124:127], v[16:31]
  ds_read_b64_tr_b16 v[120:121], v164 offset:6144
  ds_read_b64_tr_b16 v[122:123], v164 offset:6656
  v_mfma_f32_32x32x16_bf16 v[32:47], v[132:135], v[128:131], v[32:47]
  ds_read_b128 v[112:115], v168 offset:0
  ds_read_b128 v[116:119], v168 offset:4096
  s_waitcnt lgkmcnt(0)
  s_barrier
  v_mfma_f32_32x32x16_bf16 v[16:31], v[144:147], v[136:139], v[16:31]
  ds_read_b64_tr_b16 v[132:133], v164 offset:8192
  ds_read_b64_tr_b16 v[134:135], v164 offset:8704
  v_mfma_f32_32x32x16_bf16 v[32:47], v[144:147], v[140:143], v[32:47]
  ds_read_b128 v[124:127], v165 offset:16384
  ds_read_b128 v[128:131], v165 offset:20480
  s_waitcnt lgkmcnt(4)
  v_mfma_f32_32x32x16_bf16 v[16:31], v[120:123], v[112:115], v[16:31]
  ds_read_b64_tr_b16 v[144:145], v164 offset:10240
  ds_read_b64_tr_b16 v[146:147], v164 offset:10752
  v_mfma_f32_32x32x16_bf16 v[32:47], v[120:123], v[116:119], v[32:47]
  ds_read_b128 v[136:139], v166 offset:16384
  ds_read_b128 v[140:143], v166 offset:20480
  s_waitcnt lgkmcnt(4)
  v_mfma_f32_32x32x16_bf16 v[16:31], v[132:135], v[124:127], v[16:31]
  ds_read_b64_tr_b16 v[120:121], v164 offset:12288
  ds_read_b64_tr_b16 v[122:123], v164 offset:12800
  v_mfma_f32_32x32x16_bf16 v[32:47], v[132:135], v[128:131], v[32:47]
  ds_read_b128 v[112:115], v167 offset:16384
  ds_read_b128 v[116:119], v167 offset:20480
  s_waitcnt lgkmcnt(4)
  v_mfma_f32_32x32x16_bf16 v[16:31], v[144:147], v[136:139], v[16:31]
  ds_read_b64_tr_b16 v[132:133], v164 offset:14336
  ds_read_b64_tr_b16 v[134:135], v164 offset:14848
  v_mfma_f32_32x32x16_bf16 v[32:47], v[144:147], v[140:143], v[32:47]
  ds_read_b128 v[124:127], v168 offset:16384
  ds_read_b128 v[128:131], v168 offset:20480
  s_waitcnt lgkmcnt(4)
  v_mfma_f32_32x32x16_bf16 v[16:31], v[120:123], v[112:115], v[16:31]
  ds_read_b64_tr_b16 v[144:145], v164 offset:16384
  ds_read_b64_tr_b16 v[146:147], v164 offset:16896
  v_mfma_f32_32x32x16_bf16 v[32:47], v[120:123], v[116:119], v[32:47]
  ds_read_b128 v[136:139], v165 offset:32768
  ds_read_b128 v[140:143], v165 offset:36864
  s_waitcnt lgkmcnt(4)
  v_mfma_f32_32x32x16_bf16 v[16:31], v[132:135], v[124:127], v[16:31]
  ds_read_b64_tr_b16 v[120:121], v164 offset:18432
  ds_read_b64_tr_b16 v[122:123], v164 offset:18944
  v_mfma_f32_32x32x16_bf16 v[32:47], v[132:135], v[128:131], v[32:47]
  ds_read_b128 v[112:115], v166 offset:32768
  ds_read_b128 v[116:119], v166 offset:36864
  s_waitcnt lgkmcnt(4)
  v_mfma_f32_32x32x16_bf16 v[16:31], v[144:147], v[136:139], v[16:31]
  ds_read_b64_tr_b16 v[132:133], v164 offset:20480
  ds_read_b64_tr_b16 v[134:135], v164 offset:20992
  v_mfma_f32_32x32x16_bf16 v[32:47], v[144:147], v[140:143], v[32:47]
  ds_read_b128 v[124:127], v167 offset:32768
  ds_read_b128 v[128:131], v167 offset:36864
  s_waitcnt lgkmcnt(4)
  v_mfma_f32_32x32x16_bf16 v[16:31], v[120:123], v[112:115], v[16:31]
  ds_read_b64_tr_b16 v[144:145], v164 offset:22528
  ds_read_b64_tr_b16 v[146:147], v164 offset:23040
  v_mfma_f32_32x32x16_bf16 v[32:47], v[120:123], v[116:119], v[32:47]
  ds_read_b128 v[136:139], v168 offset:32768
  ds_read_b128 v[140:143], v168 offset:36864
  s_waitcnt lgkmcnt(4)
  v_mfma_f32_32x32x16_bf16 v[16:31], v[132:135], v[124:127], v[16:31]
  v_mfma_f32_32x32x16_bf16 v[32:47], v[132:135], v[128:131], v[32:47]
  s_waitcnt lgkmcnt(0)
  v_mfma_f32_32x32x16_bf16 v[16:31], v[144:147], v[136:139], v[16:31]
  v_mfma_f32_32x32x16_bf16 v[32:47], v[144:147], v[140:143], v[32:47]
  s_lshl_b32 s62, s28, 3
  s_add_u32 s62, s62, s54
  s_lshl_b32 s62, s62, 4
  s_add_u32 s62, s62, s58
  s_lshl_b32 s62, s62, 7
  s_add_u32 s63, s62, 17891328
  s_add_u32 s62, s62, 17825792
  s_waitcnt vmcnt(0)
  v_readfirstlane_b32 s50, v156
  v_readfirstlane_b32 s51, v157
  s_mov_b32 s52, 20000
LN4:
  s_cmp_lg_u32 s50, 0
  s_cbranch_scc1 LN5
  s_sub_u32 s52, s52, 1
  s_cmp_eq_u32 s52, 0
  s_cbranch_scc1 LN5
  buffer_load_dwordx2 v[156:157], v9, s[44:47], 0 offen sc1
  s_waitcnt vmcnt(0)
  v_readfirstlane_b32 s50, v156
  v_readfirstlane_b32 s51, v157
  s_branch LN4
LN5:
  s_barrier
  s_cmp_lg_u32 s31, 0
  s_cbranch_scc1 LE3
  v_mov_b32 v14, s50
  v_mov_b32 v15, s51
  s_mov_b64 exec, 1
  buffer_store_dwordx2 v[14:15], v9, s[24:27], s63 offen sc0 sc1
  s_mov_b64 exec, -1
LE3:
  s_nop 3
  v_mul_f32 v16, s34, v16
  v_mul_f32 v17, s34, v17
  v_mul_f32 v18, s34, v18
  v_mul_f32 v19, s34, v19
  v_mul_f32 v20, s34, v20
  v_mul_f32 v21, s34, v21
  v_mul_f32 v22, s34, v22
  v_mul_f32 v23, s34, v23
  v_mul_f32 v24, s34, v24
  v_mul_f32 v25, s34, v25
  v_mul_f32 v26, s34, v26
  v_mul_f32 v27, s34, v27
  v_mul_f32 v28, s34, v28
  v_mul_f32 v29, s34, v29
  v_mul_f32 v30, s34, v30
  v_mul_f32 v31, s34, v31
  v_cvt_pk_bf16_f32 v176, v16, v17
  v_cvt_pk_bf16_f32 v177, v18, v19
  v_cvt_pk_bf16_f32 v178, v20, v21
  v_cvt_pk_bf16_f32 v179, v22, v23
  v_cvt_pk_bf16_f32 v180, v24, v25
  v_cvt_pk_bf16_f32 v181, v26, v27
  v_cvt_pk_bf16_f32 v182, v28, v29
  v_cvt_pk_bf16_f32 v183, v30, v31
  v_mul_f32 v170, v16, v16
  v_fmac_f32 v170, v17, v17
  v_permlane32_swap_b32 v176, v178
  v_permlane32_swap_b32 v177, v179
  v_permlane32_swap_b32 v180, v182
  v_permlane32_swap_b32 v181, v183
  buffer_store_dwordx4 v[176:179], v8, s[24:27], s35 offen offset:0 sc1
  buffer_store_dwordx4 v[180:183], v8, s[24:27], s35 offen offset:1024 sc1
  s_add_u32 s35, s35, 32768
  v_mul_f32 v32, s34, v32
  v_mul_f32 v33, s34, v33
  v_mul_f32 v34, s34, v34
  v_mul_f32 v35, s34, v35
  v_mul_f32 v36, s34, v36
  v_mul_f32 v37, s34, v37
  v_mul_f32 v38, s34, v38
  v_mul_f32 v39, s34, v39
  v_mul_f32 v40, s34, v40
  v_mul_f32 v41, s34, v41
  v_mul_f32 v42, s34, v42
  v_mul_f32 v43, s34, v43
  v_mul_f32 v44, s34, v44
  v_mul_f32 v45, s34, v45
  v_mul_f32 v46, s34, v46
  v_mul_f32 v47, s34, v47
  v_cvt_pk_bf16_f32 v184, v32, v33
  v_cvt_pk_bf16_f32 v185, v34, v35
  v_cvt_pk_bf16_f32 v186, v36, v37
  v_cvt_pk_bf16_f32 v187, v38, v39
  v_cvt_pk_bf16_f32 v188, v40, v41
  v_cvt_pk_bf16_f32 v189, v42, v43
  v_cvt_pk_bf16_f32 v190, v44, v45
  v_cvt_pk_bf16_f32 v191, v46, v47
  v_mul_f32 v171, v32, v32
  v_fmac_f32 v171, v33, v33
  v_permlane32_swap_b32 v184, v186
  v_permlane32_swap_b32 v185, v187
  v_permlane32_swap_b32 v188, v190
  v_permlane32_swap_b32 v189, v191
  buffer_store_dwordx4 v[184:187], v8, s[24:27], s35 offen offset:0 sc1
  buffer_store_dwordx4 v[188:191], v8, s[24:27], s35 offen offset:1024 sc1
  s_add_u32 s35, s35, 0
  v_fmac_f32 v170, v18, v18
  v_fmac_f32 v171, v34, v34
  v_fmac_f32 v170, v19, v19
  v_fmac_f32 v171, v35, v35
  v_fmac_f32 v170, v20, v20
  v_fmac_f32 v171, v36, v36
  v_fmac_f32 v170, v21, v21
  v_fmac_f32 v171, v37, v37
  v_fmac_f32 v170, v22, v22
  v_fmac_f32 v171, v38, v38
  v_fmac_f32 v170, v23, v23
  v_fmac_f32 v171, v39, v39
  v_fmac_f32 v170, v24, v24
  v_fmac_f32 v171, v40, v40
  v_fmac_f32 v170, v25, v25
  v_fmac_f32 v171, v41, v41
  v_fmac_f32 v170, v26, v26
  v_fmac_f32 v171, v42, v42
  v_fmac_f32 v170, v27, v27
  v_fmac_f32 v171, v43, v43
  v_fmac_f32 v170, v28, v28
  v_fmac_f32 v171, v44, v44
  v_fmac_f32 v170, v29, v29
  v_fmac_f32 v171, v45, v45
  v_fmac_f32 v170, v30, v30
  v_fmac_f32 v171, v46, v46
  v_fmac_f32 v170, v31, v31
  v_fmac_f32 v171, v47, v47
  s_nop 1
  v_permlane32_swap_b32 v170, v171
  v_add_f32 v170, v170, v171
  s_nop 1
  v_max_f32_dpp v170, v170, v170 quad_perm:[1,0,3,2] row_mask:0xf bank_mask:0xf
  s_nop 1
  v_max_f32_dpp v170, v170, v170 quad_perm:[2,3,0,1] row_mask:0xf bank_mask:0xf
  s_nop 1
  v_max_f32_dpp v170, v170, v170 row_half_mirror row_mask:0xf bank_mask:0xf
  s_nop 1
  v_max_f32_dpp v170, v170, v170 row_mirror row_mask:0xf bank_mask:0xf
  s_nop 1
  v_max_f32_dpp v170, v170, v170 row_bcast:15 row_mask:0xa bank_mask:0xf
  s_mov_b32 exec_lo, 0x80000000
  s_mov_b32 exec_hi, 0x80000000
  buffer_store_dword v170, v159, s[24:27], s38 offen offset:0 sc1
  s_mov_b64 exec, -1
  s_branch L_PE
L_PB:
  s_mov_b32 s34, 1069066811
  v_mov_b32 v170, 3049366176
  v_mov_b32 v171, 897988541
  s_mul_i32 s43, s41, 28672
  s_add_u32 s35, s43, 8388608
  s_lshl_b32 s37, s42, 11
  s_add_u32 s37, s37, s43
  s_add_u32 s37, s37, 6291456
  s_mul_i32 s39, s41, 29184
  s_add_u32 s39, s39, 10485760
  s_barrier
  ds_read_b64_tr_b16 v[120:121], v164 offset:0
  ds_read_b64_tr_b16 v[122:123], v164 offset:512
  ds_read_b128 v[112:115], v160 offset:0
  ds_read_b128 v[116:119], v160 offset:4096
  ds_read_b64_tr_b16 v[132:133], v164 offset:2048
  ds_read_b64_tr_b16 v[134:135], v164 offset:2560
  ds_read_b128 v[124:127], v161 offset:0
  ds_read_b128 v[128:131], v161 offset:4096
  s_waitcnt lgkmcnt(4)
  v_mfma_f32_32x32x16_bf16 v[48:63], v[112:115], v[120:123], v[48:63]
  ds_read_b64_tr_b16 v[144:145], v164 offset:4096
  ds_read_b64_tr_b16 v[146:147], v164 offset:4608
  v_mfma_f32_32x32x16_bf16 v[64:79], v[116:119], v[120:123], v[64:79]
  ds_read_b128 v[136:139], v162 offset:0
  ds_read_b128 v[140:143], v162 offset:4096
  s_waitcnt lgkmcnt(4)
  v_mfma_f32_32x32x16_bf16 v[48:63], v[124:127], v[132:135], v[48:63]
  ds_read_b64_tr_b16 v[120:121], v164 offset:6144
  ds_read_b64_tr_b16 v[122:123], v164 offset:6656
  v_mfma_f32_32x32x16_bf16 v[64:79], v[128:131], v[132:135], v[64:79]
  ds_read_b128 v[112:115], v163 offset:0
  ds_read_b128 v[116:119], v163 offset:4096
  s_waitcnt lgkmcnt(0)
  s_barrier
  v_mfma_f32_32x32x16_bf16 v[48:63], v[136:139], v[144:147], v[48:63]
  ds_read_b64_tr_b16 v[132:133], v164 offset:8192
  ds_read_b64_tr_b16 v[134:135], v164 offset:8704
  v_mfma_f32_32x32x16_bf16 v[64:79], v[140:143], v[144:147], v[64:79]
  ds_read_b128 v[124:127], v160 offset:16384
  ds_read_b128 v[128:131], v160 offset:20480
  s_waitcnt lgkmcnt(4)
  v_mfma_f32_32x32x16_bf16 v[48:63], v[112:115], v[120:123], v[48:63]
  ds_read_b64_tr_b16 v[144:145], v164 offset:10240
  ds_read_b64_tr_b16 v[146:147], v164 offset:10752
  v_mfma_f32_32x32x16_bf16 v[64:79], v[116:119], v[120:123], v[64:79]
  ds_read_b128 v[136:139], v161 offset:16384
  ds_read_b128 v[140:143], v161 offset:20480
  s_waitcnt lgkmcnt(4)
  v_mfma_f32_32x32x16_bf16 v[48:63], v[124:127], v[132:135], v[48:63]
  ds_read_b64_tr_b16 v[120:121], v164 offset:12288
  ds_read_b64_tr_b16 v[122:123], v164 offset:12800
  v_mfma_f32_32x32x16_bf16 v[64:79], v[128:131], v[132:135], v[64:79]
  ds_read_b128 v[112:115], v162 offset:16384
  ds_read_b128 v[116:119], v162 offset:20480
  s_waitcnt lgkmcnt(4)
  v_mfma_f32_32x32x16_bf16 v[48:63], v[136:139], v[144:147], v[48:63]
  ds_read_b64_tr_b16 v[132:133], v164 offset:14336
  ds_read_b64_tr_b16 v[134:135], v164 offset:14848
  v_mfma_f32_32x32x16_bf16 v[64:79], v[140:143], v[144:147], v[64:79]
  ds_read_b128 v[124:127], v163 offset:16384
  ds_read_b128 v[128:131], v163 offset:20480
  s_waitcnt lgkmcnt(0)
  s_barrier
  v_mfma_f32_32x32x16_bf16 v[48:63], v[112:115], v[120:123], v[48:63]
  ds_read_b64_tr_b16 v[144:145], v164 offset:16384
  ds_read_b64_tr_b16 v[146:147], v164 offset:16896
  v_mfma_f32_32x32x16_bf16 v[64:79], v[116:119], v[120:123], v[64:79]
  ds_read_b128 v[136:139], v160 offset:32768
  ds_read_b128 v[140:143], v160 offset:36864
  s_waitcnt lgkmcnt(4)
  v_mfma_f32_32x32x16_bf16 v[48:63], v[124:127], v[132:135], v[48:63]
  ds_read_b64_tr_b16 v[120:121], v164 offset:18432
  ds_read_b64_tr_b16 v[122:123], v164 offset:18944
  v_mfma_f32_32x32x16_bf16 v[64:79], v[128:131], v[132:135], v[64:79]
  ds_read_b128 v[112:115], v161 offset:32768
  ds_read_b128 v[116:119], v161 offset:36864
  s_waitcnt lgkmcnt(4)
  v_mfma_f32_32x32x16_bf16 v[48:63], v[136:139], v[144:147], v[48:63]
  ds_read_b64_tr_b16 v[132:133], v164 offset:20480
  ds_read_b64_tr_b16 v[134:135], v164 offset:20992
  v_mfma_f32_32x32x16_bf16 v[64:79], v[140:143], v[144:147], v[64:79]
  ds_read_b128 v[124:127], v162 offset:32768
  ds_read_b128 v[128:131], v162 offset:36864
  s_waitcnt lgkmcnt(4)
  v_mfma_f32_32x32x16_bf16 v[48:63], v[112:115], v[120:123], v[48:63]
  ds_read_b64_tr_b16 v[144:145], v164 offset:22528
  ds_read_b64_tr_b16 v[146:147], v164 offset:23040
  v_mfma_f32_32x32x16_bf16 v[64:79], v[116:119], v[120:123], v[64:79]
  ds_read_b128 v[136:139], v163 offset:32768
  ds_read_b128 v[140:143], v163 offset:36864
  s_waitcnt lgkmcnt(0)
  s_barrier
  v_mfma_f32_32x32x16_bf16 v[48:63], v[124:127], v[132:135], v[48:63]
  ds_read_b64_tr_b16 v[120:121], v164 offset:24576
  ds_read_b64_tr_b16 v[122:123], v164 offset:25088
  v_mfma_f32_32x32x16_bf16 v[64:79], v[128:131], v[132:135], v[64:79]
  ds_read_b128 v[112:115], v160 offset:49152
  ds_read_b128 v[116:119], v160 offset:53248
  s_waitcnt lgkmcnt(4)
  v_mfma_f32_32x32x16_bf16 v[48:63], v[136:139], v[144:147], v[48:63]
  ds_read_b64_tr_b16 v[132:133], v164 offset:26624
  ds_read_b64_tr_b16 v[134:135], v164 offset:27136
  v_mfma_f32_32x32x16_bf16 v[64:79], v[140:143], v[144:147], v[64:79]
  ds_read_b128 v[124:127], v161 offset:49152
  ds_read_b128 v[128:131], v161 offset:53248
  s_waitcnt lgkmcnt(4)
  v_mfma_f32_32x32x16_bf16 v[48:63], v[112:115], v[120:123], v[48:63]
  ds_read_b64_tr_b16 v[144:145], v164 offset:28672
  ds_read_b64_tr_b16 v[146:147], v164 offset:29184
  v_mfma_f32_32x32x16_bf16 v[64:79], v[116:119], v[120:123], v[64:79]
  ds_read_b128 v[136:139], v162 offset:49152
  ds_read_b128 v[140:143], v162 offset:53248
  s_waitcnt lgkmcnt(4)
  v_mfma_f32_32x32x16_bf16 v[48:63], v[124:127], v[132:135], v[48:63]
  ds_read_b64_tr_b16 v[120:121], v164 offset:30720
  ds_read_b64_tr_b16 v[122:123], v164 offset:31232
  v_mfma_f32_32x32x16_bf16 v[64:79], v[128:131], v[132:135], v[64:79]
  ds_read_b128 v[112:115], v163 offset:49152
  ds_read_b128 v[116:119], v163 offset:53248
  s_waitcnt lgkmcnt(0)
  s_barrier
  v_mfma_f32_32x32x16_bf16 v[48:63], v[136:139], v[144:147], v[48:63]
  ds_read_b64_tr_b16 v[132:133], v164 offset:32768
  ds_read_b64_tr_b16 v[134:135], v164 offset:33280
  v_mfma_f32_32x32x16_bf16 v[64:79], v[140:143], v[144:147], v[64:79]
  ds_read_b128 v[124:127], v165 offset:0
  ds_read_b128 v[128:131], v165 offset:4096
  s_waitcnt lgkmcnt(4)
  v_mfma_f32_32x32x16_bf16 v[48:63], v[112:115], v[120:123], v[48:63]
  ds_read_b64_tr_b16 v[144:145], v164 offset:34816
  ds_read_b64_tr_b16 v[146:147], v164 offset:35328
  v_mfma_f32_32x32x16_bf16 v[64:79], v[116:119], v[120:123], v[64:79]
  ds_read_b128 v[136:139], v166 offset:0
  ds_read_b128 v[140:143], v166 offset:4096
  s_waitcnt lgkmcnt(4)
  v_mfma_f32_32x32x16_bf16 v[48:63], v[124:127], v[132:135], v[48:63]
  ds_read_b64_tr_b16 v[120:121], v164 offset:36864
  ds_read_b64_tr_b16 v[122:123], v164 offset:37376
  v_mfma_f32_32x32x16_bf16 v[64:79], v[128:131], v[132:135], v[64:79]
  ds_read_b128 v[112:115], v167 offset:0
  ds_read_b128 v[116:119], v167 offset:4096
  s_waitcnt lgkmcnt(4)
  v_mfma_f32_32x32x16_bf16 v[48:63], v[136:139], v[144:147], v[48:63]
  ds_read_b64_tr_b16 v[132:133], v164 offset:38912
  ds_read_b64_tr_b16 v[134:135], v164 offset:39424
  v_mfma_f32_32x32x16_bf16 v[64:79], v[140:143], v[144:147], v[64:79]
  ds_read_b128 v[124:127], v168 offset:0
  ds_read_b128 v[128:131], v168 offset:4096
  s_waitcnt lgkmcnt(0)
  s_barrier
  v_mfma_f32_32x32x16_bf16 v[48:63], v[112:115], v[120:123], v[48:63]
  ds_read_b64_tr_b16 v[144:145], v164 offset:40960
  ds_read_b64_tr_b16 v[146:147], v164 offset:41472
  v_mfma_f32_32x32x16_bf16 v[64:79], v[116:119], v[120:123], v[64:79]
  ds_read_b128 v[136:139], v165 offset:16384
  ds_read_b128 v[140:143], v165 offset:20480
  s_waitcnt lgkmcnt(4)
  v_mfma_f32_32x32x16_bf16 v[48:63], v[124:127], v[132:135], v[48:63]
  ds_read_b64_tr_b16 v[120:121], v164 offset:43008
  ds_read_b64_tr_b16 v[122:123], v164 offset:43520
  v_mfma_f32_32x32x16_bf16 v[64:79], v[128:131], v[132:135], v[64:79]
  ds_read_b128 v[112:115], v166 offset:16384
  ds_read_b128 v[116:119], v166 offset:20480
  s_waitcnt lgkmcnt(4)
  v_mfma_f32_32x32x16_bf16 v[48:63], v[136:139], v[144:147], v[48:63]
  ds_read_b64_tr_b16 v[132:133], v164 offset:45056
  ds_read_b64_tr_b16 v[134:135], v164 offset:45568
  v_mfma_f32_32x32x16_bf16 v[64:79], v[140:143], v[144:147], v[64:79]
  ds_read_b128 v[124:127], v167 offset:16384
  ds_read_b128 v[128:131], v167 offset:20480
  s_waitcnt lgkmcnt(4)
  v_mfma_f32_32x32x16_bf16 v[48:63], v[112:115], v[120:123], v[48:63]
  ds_read_b64_tr_b16 v[144:145], v164 offset:47104
  ds_read_b64_tr_b16 v[146:147], v164 offset:47616
  v_mfma_f32_32x32x16_bf16 v[64:79], v[116:119], v[120:123], v[64:79]
  ds_read_b128 v[136:139], v168 offset:16384
  ds_read_b128 v[140:143], v168 offset:20480
  s_waitcnt lgkmcnt(0)
  s_barrier
  v_mfma_f32_32x32x16_bf16 v[48:63], v[124:127], v[132:135], v[48:63]
  ds_read_b64_tr_b16 v[120:121], v164 offset:0
  ds_read_b64_tr_b16 v[122:123], v164 offset:512
  v_mfma_f32_32x32x16_bf16 v[64:79], v[128:131], v[132:135], v[64:79]
  ds_read_b128 v[112:115], v165 offset:32768
  ds_read_b128 v[116:119], v165 offset:36864
  s_waitcnt lgkmcnt(4)
  v_mfma_f32_32x32x16_bf16 v[48:63], v[136:139], v[144:147], v[48:63]
  ds_read_b64_tr_b16 v[132:133], v164 offset:2048
  ds_read_b64_tr_b16 v[134:135], v164 offset:2560
  v_mfma_f32_32x32x16_bf16 v[64:79], v[140:143], v[144:147], v[64:79]
  ds_read_b128 v[124:127], v166 offset:32768
  ds_read_b128 v[128:131], v166 offset:36864
  s_waitcnt lgkmcnt(4)
  v_mfma_f32_32x32x16_bf16 v[48:63], v[112:115], v[120:123], v[48:63]
  ds_read_b64_tr_b16 v[144:145], v164 offset:4096
  ds_read_b64_tr_b16 v[146:147], v164 offset:4608
  v_mfma_f32_32x32x16_bf16 v[64:79], v[116:119], v[120:123], v[64:79]
  ds_read_b128 v[136:139], v167 offset:32768
  ds_read_b128 v[140:143], v167 offset:36864
  s_waitcnt lgkmcnt(4)
  v_mfma_f32_32x32x16_bf16 v[48:63], v[124:127], v[132:135], v[48:63]
  ds_read_b64_tr_b16 v[120:121], v164 offset:6144
  ds_read_b64_tr_b16 v[122:123], v164 offset:6656
  v_mfma_f32_32x32x16_bf16 v[64:79], v[128:131], v[132:135], v[64:79]
  ds_read_b128 v[112:115], v168 offset:32768
  ds_read_b128 v[116:119], v168 offset:36864
  s_waitcnt lgkmcnt(0)
  s_barrier
  v_mfma_f32_32x32x16_bf16 v[48:63], v[136:139], v[144:147], v[48:63]
  ds_read_b64_tr_b16 v[132:133], v164 offset:8192
  ds_read_b64_tr_b16 v[134:135], v164 offset:8704
  v_mfma_f32_32x32x16_bf16 v[64:79], v[140:143], v[144:147], v[64:79]
  ds_read_b128 v[124:127], v160 offset:0
  ds_read_b128 v[128:131], v160 offset:4096
  s_waitcnt lgkmcnt(4)
  v_mfma_f32_32x32x16_bf16 v[48:63], v[112:115], v[120:123], v[48:63]
  ds_read_b64_tr_b16 v[144:145], v164 offset:10240
  ds_read_b64_tr_b16 v[146:147], v164 offset:10752
  v_mfma_f32_32x32x16_bf16 v[64:79], v[116:119], v[120:123], v[64:79]
  ds_read_b128 v[136:139], v161 offset:0
  ds_read_b128 v[140:143], v161 offset:4096
  s_waitcnt lgkmcnt(4)
  v_mfma_f32_32x32x16_bf16 v[80:95], v[124:127], v[132:135], 0
  ds_read_b64_tr_b16 v[120:121], v164 offset:12288
  ds_read_b64_tr_b16 v[122:123], v164 offset:12800
  v_mfma_f32_32x32x16_bf16 v[96:111], v[128:131], v[132:135], 0
  ds_read_b128 v[112:115], v162 offset:0
  ds_read_b128 v[116:119], v162 offset:4096
  s_waitcnt lgkmcnt(4)
  v_mfma_f32_32x32x16_bf16 v[80:95], v[136:139], v[144:147], v[80:95]
  ds_read_b64_tr_b16 v[132:133], v164 offset:14336
  ds_read_b64_tr_b16 v[134:135], v164 offset:14848
  v_mfma_f32_32x32x16_bf16 v[96:111], v[140:143], v[144:147], v[96:111]
  ds_read_b128 v[124:127], v163 offset:0
  ds_read_b128 v[128:131], v163 offset:4096
  s_waitcnt lgkmcnt(4)
  v_mfma_f32_32x32x16_bf16 v[80:95], v[112:115], v[120:123], v[80:95]
  ds_read_b64_tr_b16 v[144:145], v164 offset:16384
  ds_read_b64_tr_b16 v[146:147], v164 offset:16896
  v_fma_f32 v176, v48, s34, v170
  v_fma_f32 v177, v49, s34, v170
  v_fma_f32 v178, v50, s34, v170
  v_mfma_f32_32x32x16_bf16 v[96:111], v[116:119], v[120:123], v[96:111]
  ds_read_b128 v[136:139], v160 offset:16384
  ds_read_b128 v[140:143], v160 offset:20480
  v_fma_f32 v179, v51, s34, v170
  v_fma_f32 v180, v52, s34, v170
  v_fma_f32 v181, v53, s34, v170
  s_waitcnt lgkmcnt(4)
  v_mfma_f32_32x32x16_bf16 v[80:95], v[124:127], v[132:135], v[80:95]
  ds_read_b64_tr_b16 v[120:121], v164 offset:18432
  ds_read_b64_tr_b16 v[122:123], v164 offset:18944
  v_fma_f32 v182, v54, s34, v170
  v_fma_f32 v183, v55, s34, v170
  v_fma_f32 v184, v56, s34, v170
  v_mfma_f32_32x32x16_bf16 v[96:111], v[128:131], v[132:135], v[96:111]
  ds_read_b128 v[112:115], v161 offset:16384
  ds_read_b128 v[116:119], v161 offset:20480
  v_fma_f32 v185, v57, s34, v170
  v_fma_f32 v186, v58, s34, v170
  v_fma_f32 v187, v59, s34, v170
  s_waitcnt lgkmcnt(4)
  v_mfma_f32_32x32x16_bf16 v[80:95], v[136:139], v[144:147], v[80:95]
  ds_read_b64_tr_b16 v[132:133], v164 offset:20480
  ds_read_b64_tr_b16 v[134:135], v164 offset:20992
  v_fma_f32 v188, v60, s34, v170
  v_fma_f32 v189, v61, s34, v170
  v_fma_f32 v190, v62, s34, v170
  v_mfma_f32_32x32x16_bf16 v[96:111], v[140:143], v[144:147], v[96:111]
  ds_read_b128 v[124:127], v162 offset:16384
  ds_read_b128 v[128:131], v162 offset:20480
  v_fma_f32 v191, v63, s34, v170
  v_exp_f32 v176, v176 clamp
  v_max_f32 v48, v48, v171
  s_waitcnt lgkmcnt(4)
  v_mfma_f32_32x32x16_bf16 v[80:95], v[112:115], v[120:123], v[80:95]
  ds_read_b64_tr_b16 v[144:145], v164 offset:22528
  ds_read_b64_tr_b16 v[146:147], v164 offset:23040
  v_exp_f32 v177, v177 clamp
  v_max_f32 v49, v49, v171
  v_exp_f32 v178, v178 clamp
  v_mfma_f32_32x32x16_bf16 v[96:111], v[116:119], v[120:123], v[96:111]
  ds_read_b128 v[136:139], v163 offset:16384
  ds_read_b128 v[140:143], v163 offset:20480
  v_max_f32 v50, v50, v171
  v_exp_f32 v179, v179 clamp
  v_max_f32 v51, v51, v171
  s_waitcnt lgkmcnt(0)
  s_barrier
  v_mfma_f32_32x32x16_bf16 v[80:95], v[124:127], v[132:135], v[80:95]
  ds_read_b64_tr_b16 v[120:121], v164 offset:24576
  ds_read_b64_tr_b16 v[122:123], v164 offset:25088
  v_exp_f32 v180, v180 clamp
  v_max_f32 v52, v52, v171
  v_exp_f32 v181, v181 clamp
  v_mfma_f32_32x32x16_bf16 v[96:111], v[128:131], v[132:135], v[96:111]
  ds_read_b128 v[112:115], v160 offset:32768
  ds_read_b128 v[116:119], v160 offset:36864
  v_max_f32 v53, v53, v171
  v_exp_f32 v182, v182 clamp
  v_max_f32 v54, v54, v171
  s_waitcnt lgkmcnt(4)
  v_mfma_f32_32x32x16_bf16 v[80:95], v[136:139], v[144:147], v[80:95]
  ds_read_b64_tr_b16 v[132:133], v164 offset:26624
  ds_read_b64_tr_b16 v[134:135], v164 offset:27136
  v_exp_f32 v183, v183 clamp
  v_max_f32 v55, v55, v171
  v_exp_f32 v184, v184 clamp
  v_mfma_f32_32x32x16_bf16 v[96:111], v[140:143], v[144:147], v[96:111]
  ds_read_b128 v[124:127], v161 offset:32768
  ds_read_b128 v[128:131], v161 offset:36864
  v_max_f32 v56, v56, v171
  v_exp_f32 v185, v185 clamp
  v_max_f32 v57, v57, v171
  s_waitcnt lgkmcnt(4)
  v_mfma_f32_32x32x16_bf16 v[80:95], v[112:115], v[120:123], v[80:95]
  ds_read_b64_tr_b16 v[144:145], v164 offset:28672
  ds_read_b64_tr_b16 v[146:147], v164 offset:29184
  v_exp_f32 v186, v186 clamp
  v_max_f32 v58, v58, v171
  v_exp_f32 v187, v187 clamp
  v_mfma_f32_32x32x16_bf16 v[96:111], v[116:119], v[120:123], v[96:111]
  ds_read_b128 v[136:139], v162 offset:32768
  ds_read_b128 v[140:143], v162 offset:36864
  v_max_f32 v59, v59, v171
  v_exp_f32 v188, v188 clamp
  v_max_f32 v60, v60, v171
  s_waitcnt lgkmcnt(4)
  v_mfma_f32_32x32x16_bf16 v[80:95], v[124:127], v[132:135], v[80:95]
  ds_read_b64_tr_b16 v[120:121], v164 offset:30720
  ds_read_b64_tr_b16 v[122:123], v164 offset:31232
  v_exp_f32 v189, v189 clamp
  v_max_f32 v61, v61, v171
  v_exp_f32 v190, v190 clamp
  v_mfma_f32_32x32x16_bf16 v[96:111], v[128:131], v[132:135], v[96:111]
  ds_read_b128 v[112:115], v163 offset:32768
  ds_read_b128 v[116:119], v163 offset:36864
  v_max_f32 v62, v62, v171
  v_exp_f32 v191, v191 clamp
  v_max_f32 v63, v63, v171
  s_waitcnt lgkmcnt(4)
  v_mfma_f32_32x32x16_bf16 v[80:95], v[136:139], v[144:147], v[80:95]
  ds_read_b64_tr_b16 v[132:133], v164 offset:32768
  ds_read_b64_tr_b16 v[134:135], v164 offset:33280
  v_add_f32 v48, v48, v176
  v_add_f32 v49, v49, v177
  v_add_f32 v50, v50, v178
  v_mfma_f32_32x32x16_bf16 v[96:111], v[140:143], v[144:147], v[96:111]
  ds_read_b128 v[124:127], v160 offset:49152
  ds_read_b128 v[128:131], v160 offset:53248
  v_add_f32 v51, v51, v179
  v_add_f32 v52, v52, v180
  v_add_f32 v53, v53, v181
  s_waitcnt lgkmcnt(4)
  v_mfma_f32_32x32x16_bf16 v[80:95], v[112:115], v[120:123], v[80:95]
  ds_read_b64_tr_b16 v[144:145], v164 offset:34816
  ds_read_b64_tr_b16 v[146:147], v164 offset:35328
  v_add_f32 v54, v54, v182
  v_add_f32 v55, v55, v183
  v_add_f32 v56, v56, v184
  v_mfma_f32_32x32x16_bf16 v[96:111], v[116:119], v[120:123], v[96:111]
  ds_read_b128 v[136:139], v161 offset:49152
  ds_read_b128 v[140:143], v161 offset:53248
  v_add_f32 v57, v57, v185
  v_add_f32 v58, v58, v186
  v_add_f32 v59, v59, v187
  s_waitcnt lgkmcnt(4)
  v_mfma_f32_32x32x16_bf16 v[80:95], v[124:127], v[132:135], v[80:95]
  ds_read_b64_tr_b16 v[120:121], v164 offset:36864
  ds_read_b64_tr_b16 v[122:123], v164 offset:37376
  v_add_f32 v60, v60, v188
  v_add_f32 v61, v61, v189
  v_add_f32 v62, v62, v190
  v_mfma_f32_32x32x16_bf16 v[96:111], v[128:131], v[132:135], v[96:111]
  ds_read_b128 v[112:115], v162 offset:49152
  ds_read_b128 v[116:119], v162 offset:53248
  v_add_f32 v63, v63, v191
  v_cvt_pk_bf16_f32 v192, v48, v49
  v_cvt_pk_bf16_f32 v193, v50, v51
  s_waitcnt lgkmcnt(4)
  v_mfma_f32_32x32x16_bf16 v[80:95], v[136:139], v[144:147], v[80:95]
  ds_read_b64_tr_b16 v[132:133], v164 offset:38912
  ds_read_b64_tr_b16 v[134:135], v164 offset:39424
  v_cvt_pk_bf16_f32 v194, v52, v53
  v_cvt_pk_bf16_f32 v195, v54, v55
  v_cvt_pk_bf16_f32 v196, v56, v57
  v_mfma_f32_32x32x16_bf16 v[96:111], v[140:143], v[144:147], v[96:111]
  ds_read_b128 v[124:127], v163 offset:49152
  ds_read_b128 v[128:131], v163 offset:53248
  v_cvt_pk_bf16_f32 v197, v58, v59
  v_cvt_pk_bf16_f32 v198, v60, v61
  v_cvt_pk_bf16_f32 v199, v62, v63
  s_waitcnt lgkmcnt(0)
  s_barrier
  v_mfma_f32_32x32x16_bf16 v[80:95], v[112:115], v[120:123], v[80:95]
  ds_read_b64_tr_b16 v[144:145], v164 offset:40960
  ds_read_b64_tr_b16 v[146:147], v164 offset:41472
  buffer_store_dwordx4 v[192:195], v154, s[24:27], s35 offen offset:0 sc1
  s_add_u32 s35, s35, 14336
  buffer_store_dwordx4 v[196:199], v154, s[24:27], s35 offen offset:0 sc1
  s_add_u32 s35, s35, 14336
  v_fma_f32 v176, v64, s34, v170
  v_mfma_f32_32x32x16_bf16 v[96:111], v[116:119], v[120:123], v[96:111]
  ds_read_b128 v[136:139], v165 offset:0
  ds_read_b128 v[140:143], v165 offset:4096
  v_fma_f32 v177, v65, s34, v170
  v_fma_f32 v178, v66, s34, v170
  v_fma_f32 v179, v67, s34, v170
  s_waitcnt lgkmcnt(4)
  v_mfma_f32_32x32x16_bf16 v[80:95], v[124:127], v[132:135], v[80:95]
  ds_read_b64_tr_b16 v[120:121], v164 offset:43008
  ds_read_b64_tr_b16 v[122:123], v164 offset:43520
  v_fma_f32 v180, v68, s34, v170
  v_fma_f32 v181, v69, s34, v170
  v_fma_f32 v182, v70, s34, v170
  v_mfma_f32_32x32x16_bf16 v[96:111], v[128:131], v[132:135], v[96:111]
  ds_read_b128 v[112:115], v166 offset:0
  ds_read_b128 v[116:119], v166 offset:4096
  v_fma_f32 v183, v71, s34, v170
  v_fma_f32 v184, v72, s34, v170
  v_fma_f32 v185, v73, s34, v170
  s_waitcnt lgkmcnt(4)
  v_mfma_f32_32x32x16_bf16 v[80:95], v[136:139], v[144:147], v[80:95]
  ds_read_b64_tr_b16 v[132:133], v164 offset:45056
  ds_read_b64_tr_b16 v[134:135], v164 offset:45568
  v_fma_f32 v186, v74, s34, v170
  v_fma_f32 v187, v75, s34, v170
  v_fma_f32 v188, v76, s34, v170
  v_mfma_f32_32x32x16_bf16 v[96:111], v[140:143], v[144:147], v[96:111]
  ds_read_b128 v[124:127], v167 offset:0
  ds_read_b128 v[128:131], v167 offset:4096
  v_fma_f32 v189, v77, s34, v170
  v_fma_f32 v190, v78, s34, v170
  v_fma_f32 v191, v79, s34, v170
  s_waitcnt lgkmcnt(4)
  v_mfma_f32_32x32x16_bf16 v[80:95], v[112:115], v[120:123], v[80:95]
  ds_read_b64_tr_b16 v[144:145], v164 offset:47104
  ds_read_b64_tr_b16 v[146:147], v164 offset:47616
  v_exp_f32 v176, v176 clamp
  v_max_f32 v64, v64, v171
  v_exp_f32 v177, v177 clamp
  v_mfma_f32_32x32x16_bf16 v[96:111], v[116:119], v[120:123], v[96:111]
  ds_read_b128 v[136:139], v168 offset:0
  ds_read_b128 v[140:143], v168 offset:4096
  v_max_f32 v65, v65, v171
  v_exp_f32 v178, v178 clamp
  v_max_f32 v66, v66, v171
  s_waitcnt lgkmcnt(4)
  v_mfma_f32_32x32x16_bf16 v[80:95], v[124:127], v[132:135], v[80:95]
  ds_read_b64_tr_b16 v[120:121], v164 offset:0
  ds_read_b64_tr_b16 v[122:123], v164 offset:512
  v_exp_f32 v179, v179 clamp
  v_max_f32 v67, v67, v171
  v_exp_f32 v180, v180 clamp
  v_mfma_f32_32x32x16_bf16 v[96:111], v[128:131], v[132:135], v[96:111]
  ds_read_b128 v[112:115], v165 offset:16384
  ds_read_b128 v[116:119], v165 offset:20480
  v_max_f32 v68, v68, v171
  v_exp_f32 v181, v181 clamp
  v_max_f32 v69, v69, v171
  s_waitcnt lgkmcnt(4)
  v_mfma_f32_32x32x16_bf16 v[80:95], v[136:139], v[144:147], v[80:95]
  ds_read_b64_tr_b16 v[132:133], v164 offset:2048
  ds_read_b64_tr_b16 v[134:135], v164 offset:2560
  v_exp_f32 v182, v182 clamp
  v_max_f32 v70, v70, v171
  v_exp_f32 v183, v183 clamp
  v_mfma_f32_32x32x16_bf16 v[96:111], v[140:143], v[144:147], v[96:111]
  ds_read_b128 v[124:127], v166 offset:16384
  ds_read_b128 v[128:131], v166 offset:20480
  v_max_f32 v71, v71, v171
  v_exp_f32 v184, v184 clamp
  v_max_f32 v72, v72, v171
  s_waitcnt lgkmcnt(4)
  v_mfma_f32_32x32x16_bf16 v[80:95], v[112:115], v[120:123], v[80:95]
  ds_read_b64_tr_b16 v[144:145], v164 offset:4096
  ds_read_b64_tr_b16 v[146:147], v164 offset:4608
  v_exp_f32 v185, v185 clamp
  v_max_f32 v73, v73, v171
  v_exp_f32 v186, v186 clamp
  v_mfma_f32_32x32x16_bf16 v[96:111], v[116:119], v[120:123], v[96:111]
  ds_read_b128 v[136:139], v167 offset:16384
  ds_read_b128 v[140:143], v167 offset:20480
  v_max_f32 v74, v74, v171
  v_exp_f32 v187, v187 clamp
  v_max_f32 v75, v75, v171
  s_waitcnt lgkmcnt(4)
  v_mfma_f32_32x32x16_bf16 v[80:95], v[124:127], v[132:135], v[80:95]
  ds_read_b64_tr_b16 v[120:121], v164 offset:6144
  ds_read_b64_tr_b16 v[122:123], v164 offset:6656
  v_exp_f32 v188, v188 clamp
  v_max_f32 v76, v76, v171
  v_exp_f32 v189, v189 clamp
  v_mfma_f32_32x32x16_bf16 v[96:111], v[128:131], v[132:135], v[96:111]
  ds_read_b128 v[112:115], v168 offset:16384
  ds_read_b128 v[116:119], v168 offset:20480
  v_max_f32 v77, v77, v171
  v_exp_f32 v190, v190 clamp
  v_max_f32 v78, v78, v171
  s_waitcnt lgkmcnt(0)
  s_barrier
  v_mfma_f32_32x32x16_bf16 v[80:95], v[136:139], v[144:147], v[80:95]
  ds_read_b64_tr_b16 v[132:133], v164 offset:8192
  ds_read_b64_tr_b16 v[134:135], v164 offset:8704
  v_exp_f32 v191, v191 clamp
  v_max_f32 v79, v79, v171
  v_add_f32 v64, v64, v176
  v_mfma_f32_32x32x16_bf16 v[96:111], v[140:143], v[144:147], v[96:111]
  ds_read_b128 v[124:127], v165 offset:32768
  ds_read_b128 v[128:131], v165 offset:36864
  v_add_f32 v65, v65, v177
  v_add_f32 v66, v66, v178
  v_add_f32 v67, v67, v179
  s_waitcnt lgkmcnt(4)
  v_mfma_f32_32x32x16_bf16 v[80:95], v[112:115], v[120:123], v[80:95]
  ds_read_b64_tr_b16 v[144:145], v164 offset:10240
  ds_read_b64_tr_b16 v[146:147], v164 offset:10752
  v_add_f32 v68, v68, v180
  v_add_f32 v69, v69, v181
  v_add_f32 v70, v70, v182
  v_mfma_f32_32x32x16_bf16 v[96:111], v[116:119], v[120:123], v[96:111]
  ds_read_b128 v[136:139], v166 offset:32768
  ds_read_b128 v[140:143], v166 offset:36864
  v_add_f32 v71, v71, v183
  v_add_f32 v72, v72, v184
  v_add_f32 v73, v73, v185
  s_waitcnt lgkmcnt(4)
  v_mfma_f32_32x32x16_bf16 v[80:95], v[124:127], v[132:135], v[80:95]
  ds_read_b64_tr_b16 v[120:121], v164 offset:12288
  ds_read_b64_tr_b16 v[122:123], v164 offset:12800
  v_add_f32 v74, v74, v186
  v_add_f32 v75, v75, v187
  v_add_f32 v76, v76, v188
  v_mfma_f32_32x32x16_bf16 v[96:111], v[128:131], v[132:135], v[96:111]
  ds_read_b128 v[112:115], v167 offset:32768
  ds_read_b128 v[116:119], v167 offset:36864
  v_add_f32 v77, v77, v189
  v_add_f32 v78, v78, v190
  v_add_f32 v79, v79, v191
  s_waitcnt lgkmcnt(4)
  v_mfma_f32_32x32x16_bf16 v[80:95], v[136:139], v[144:147], v[80:95]
  ds_read_b64_tr_b16 v[132:133], v164 offset:14336
  ds_read_b64_tr_b16 v[134:135], v164 offset:14848
  v_cvt_pk_bf16_f32 v200, v64, v65
  v_cvt_pk_bf16_f32 v201, v66, v67
  v_cvt_pk_bf16_f32 v202, v68, v69
  v_mfma_f32_32x32x16_bf16 v[96:111], v[140:143], v[144:147], v[96:111]
  ds_read_b128 v[124:127], v168 offset:32768
  ds_read_b128 v[128:131], v168 offset:36864
  v_cvt_pk_bf16_f32 v203, v70, v71
  v_cvt_pk_bf16_f32 v204, v72, v73
  v_cvt_pk_bf16_f32 v205, v74, v75
  s_waitcnt lgkmcnt(4)
  v_mfma_f32_32x32x16_bf16 v[80:95], v[112:115], v[120:123], v[80:95]
  ds_read_b64_tr_b16 v[144:145], v164 offset:16384
  ds_read_b64_tr_b16 v[146:147], v164 offset:16896
  v_cvt_pk_bf16_f32 v206, v76, v77
  v_cvt_pk_bf16_f32 v207, v78, v79
  buffer_store_dwordx4 v[200:203], v154, s[24:27], s35 offen offset:0 sc1
  s_add_u32 s35, s35, 14336
  v_mfma_f32_32x32x16_bf16 v[96:111], v[116:119], v[120:123], v[96:111]
  ds_read_b128 v[136:139], v160 offset:0
  ds_read_b128 v[140:143], v160 offset:4096
  buffer_store_dwordx4 v[204:207], v154, s[24:27], s35 offen offset:0 sc1
  s_add_u32 s35, s35, 14336
  s_waitcnt lgkmcnt(4)
  v_mfma_f32_32x32x16_bf16 v[80:95], v[124:127], v[132:135], v[80:95]
  ds_read_b64_tr_b16 v[120:121], v164 offset:18432
  ds_read_b64_tr_b16 v[122:123], v164 offset:18944
  v_mfma_f32_32x32x16_bf16 v[96:111], v[128:131], v[132:135], v[96:111]
  ds_read_b128 v[112:115], v161 offset:0
  ds_read_b128 v[116:119], v161 offset:4096
  s_waitcnt lgkmcnt(4)
  v_mfma_f32_32x32x16_bf16 v[16:31], v[144:147], v[136:139], v[16:31]
  ds_read_b64_tr_b16 v[132:133], v164 offset:20480
  ds_read_b64_tr_b16 v[134:135], v164 offset:20992
  v_mfma_f32_32x32x16_bf16 v[32:47], v[144:147], v[140:143], v[32:47]
  ds_read_b128 v[124:127], v162 offset:0
  ds_read_b128 v[128:131], v162 offset:4096
  s_waitcnt lgkmcnt(4)
  v_mfma_f32_32x32x16_bf16 v[16:31], v[120:123], v[112:115], v[16:31]
  ds_read_b64_tr_b16 v[144:145], v164 offset:22528
  ds_read_b64_tr_b16 v[146:147], v164 offset:23040
  v_mfma_f32_32x32x16_bf16 v[32:47], v[120:123], v[116:119], v[32:47]
  ds_read_b128 v[136:139], v163 offset:0
  ds_read_b128 v[140:143], v163 offset:4096
  s_waitcnt lgkmcnt(0)
  s_barrier
  v_mfma_f32_32x32x16_bf16 v[16:31], v[132:135], v[124:127], v[16:31]
  ds_read_b64_tr_b16 v[120:121], v164 offset:24576
  ds_read_b64_tr_b16 v[122:123], v164 offset:25088
  v_cvt_pk_bf16_f32 v208, v80, v81
  v_cvt_pk_bf16_f32 v209, v82, v83
  v_cvt_pk_bf16_f32 v210, v84, v85
  v_mfma_f32_32x32x16_bf16 v[32:47], v[132:135], v[128:131], v[32:47]
  ds_read_b128 v[112:115], v160 offset:16384
  ds_read_b128 v[116:119], v160 offset:20480
  v_cvt_pk_bf16_f32 v211, v86, v87
  v_cvt_pk_bf16_f32 v212, v88, v89
  v_cvt_pk_bf16_f32 v213, v90, v91
  s_waitcnt lgkmcnt(4)
  v_mfma_f32_32x32x16_bf16 v[16:31], v[144:147], v[136:139], v[16:31]
  ds_read_b64_tr_b16 v[132:133], v164 offset:26624
  ds_read_b64_tr_b16 v[134:135], v164 offset:27136
  v_cvt_pk_bf16_f32 v214, v92, v93
  v_cvt_pk_bf16_f32 v215, v94, v95
  buffer_store_dwordx4 v[208:211], v155, s[24:27], s39 offen offset:0 sc1
  s_add_u32 s39, s39, 14592
  v_mfma_f32_32x32x16_bf16 v[32:47], v[144:147], v[140:143], v[32:47]
  ds_read_b128 v[124:127], v161 offset:16384
  ds_read_b128 v[128:131], v161 offset:20480
  buffer_store_dwordx4 v[212:215], v155, s[24:27], s39 offen offset:0 sc1
  s_add_u32 s39, s39, 14592
  v_cvt_pk_bf16_f32 v216, v96, v97
  v_cvt_pk_bf16_f32 v217, v98, v99
  s_waitcnt lgkmcnt(4)
  v_mfma_f32_32x32x16_bf16 v[16:31], v[120:123], v[112:115], v[16:31]
  ds_read_b64_tr_b16 v[144:145], v164 offset:28672
  ds_read_b64_tr_b16 v[146:147], v164 offset:29184
  v_cvt_pk_bf16_f32 v218, v100, v101
  v_cvt_pk_bf16_f32 v219, v102, v103
  v_cvt_pk_bf16_f32 v220, v104, v105
  v_mfma_f32_32x32x16_bf16 v[32:47], v[120:123], v[116:119], v[32:47]
  ds_read_b128 v[136:139], v162 offset:16384
  ds_read_b128 v[140:143], v162 offset:20480
  v_cvt_pk_bf16_f32 v221, v106, v107
  v_cvt_pk_bf16_f32 v222, v108, v109
  v_cvt_pk_bf16_f32 v223, v110, v111
  s_waitcnt lgkmcnt(4)
  v_mfma_f32_32x32x16_bf16 v[16:31], v[132:135], v[124:127], v[16:31]
  ds_read_b64_tr_b16 v[120:121], v164 offset:30720
  ds_read_b64_tr_b16 v[122:123], v164 offset:31232
  buffer_store_dwordx4 v[216:219], v155, s[24:27], s39 offen offset:0 sc1
  s_add_u32 s39, s39, 14592
  buffer_store_dwordx4 v[220:223], v155, s[24:27], s39 offen offset:0 sc1
  s_add_u32 s39, s39, 14592
  v_mfma_f32_32x32x16_bf16 v[32:47], v[132:135], v[128:131], v[32:47]
  ds_read_b128 v[112:115], v163 offset:16384
  ds_read_b128 v[116:119], v163 offset:20480
  s_waitcnt lgkmcnt(4)
  v_mfma_f32_32x32x16_bf16 v[16:31], v[144:147], v[136:139], v[16:31]
  ds_read_b64_tr_b16 v[132:133], v164 offset:32768
  ds_read_b64_tr_b16 v[134:135], v164 offset:33280
  v_mfma_f32_32x32x16_bf16 v[32:47], v[144:147], v[140:143], v[32:47]
  ds_read_b128 v[124:127], v160 offset:32768
  ds_read_b128 v[128:131], v160 offset:36864
  s_waitcnt lgkmcnt(4)
  v_mfma_f32_32x32x16_bf16 v[16:31], v[120:123], v[112:115], v[16:31]
  ds_read_b64_tr_b16 v[144:145], v164 offset:34816
  ds_read_b64_tr_b16 v[146:147], v164 offset:35328
  v_mfma_f32_32x32x16_bf16 v[32:47], v[120:123], v[116:119], v[32:47]
  ds_read_b128 v[136:139], v161 offset:32768
  ds_read_b128 v[140:143], v161 offset:36864
  s_waitcnt lgkmcnt(4)
  v_mfma_f32_32x32x16_bf16 v[16:31], v[132:135], v[124:127], v[16:31]
  ds_read_b64_tr_b16 v[120:121], v164 offset:36864
  ds_read_b64_tr_b16 v[122:123], v164 offset:37376
  v_mfma_f32_32x32x16_bf16 v[32:47], v[132:135], v[128:131], v[32:47]
  ds_read_b128 v[112:115], v162 offset:32768
  ds_read_b128 v[116:119], v162 offset:36864
  s_waitcnt lgkmcnt(4)
  v_mfma_f32_32x32x16_bf16 v[16:31], v[144:147], v[136:139], v[16:31]
  ds_read_b64_tr_b16 v[132:133], v164 offset:38912
  ds_read_b64_tr_b16 v[134:135], v164 offset:39424
  v_mfma_f32_32x32x16_bf16 v[32:47], v[144:147], v[140:143], v[32:47]
  ds_read_b128 v[124:127], v163 offset:32768
  ds_read_b128 v[128:131], v163 offset:36864
  s_waitcnt lgkmcnt(0)
  s_barrier
  v_mfma_f32_32x32x16_bf16 v[16:31], v[120:123], v[112:115], v[16:31]
  ds_read_b64_tr_b16 v[144:145], v164 offset:40960
  ds_read_b64_tr_b16 v[146:147], v164 offset:41472
  v_mfma_f32_32x32x16_bf16 v[32:47], v[120:123], v[116:119], v[32:47]
  ds_read_b128 v[136:139], v160 offset:49152
  ds_read_b128 v[140:143], v160 offset:53248
  s_waitcnt lgkmcnt(4)
  v_mfma_f32_32x32x16_bf16 v[16:31], v[132:135], v[124:127], v[16:31]
  ds_read_b64_tr_b16 v[120:121], v164 offset:43008
  ds_read_b64_tr_b16 v[122:123], v164 offset:43520
  v_mfma_f32_32x32x16_bf16 v[32:47], v[132:135], v[128:131], v[32:47]
  ds_read_b128 v[112:115], v161 offset:49152
  ds_read_b128 v[116:119], v161 offset:53248
  s_waitcnt lgkmcnt(4)
  v_mfma_f32_32x32x16_bf16 v[16:31], v[144:147], v[136:139], v[16:31]
  ds_read_b64_tr_b16 v[132:133], v164 offset:45056
  ds_read_b64_tr_b16 v[134:135], v164 offset:45568
  v_mfma_f32_32x32x16_bf16 v[32:47], v[144:147], v[140:143], v[32:47]
  ds_read_b128 v[124:127], v162 offset:49152
  ds_read_b128 v[128:131], v162 offset:53248
  s_waitcnt lgkmcnt(4)
  v_mfma_f32_32x32x16_bf16 v[16:31], v[120:123], v[112:115], v[16:31]
  ds_read_b64_tr_b16 v[144:145], v164 offset:47104
  ds_read_b64_tr_b16 v[146:147], v164 offset:47616
  v_mfma_f32_32x32x16_bf16 v[32:47], v[120:123], v[116:119], v[32:47]
  ds_read_b128 v[136:139], v163 offset:49152
  ds_read_b128 v[140:143], v163 offset:53248
  s_waitcnt lgkmcnt(4)
  v_mfma_f32_32x32x16_bf16 v[16:31], v[132:135], v[124:127], v[16:31]
  ds_read_b64_tr_b16 v[120:121], v164 offset:0
  ds_read_b64_tr_b16 v[122:123], v164 offset:512
  v_mfma_f32_32x32x16_bf16 v[32:47], v[132:135], v[128:131], v[32:47]
  ds_read_b128 v[112:115], v165 offset:0
  ds_read_b128 v[116:119], v165 offset:4096
  s_waitcnt lgkmcnt(4)
  v_mfma_f32_32x32x16_bf16 v[16:31], v[144:147], v[136:139], v[16:31]
  ds_read_b64_tr_b16 v[132:133], v164 offset:2048
  ds_read_b64_tr_b16 v[134:135], v164 offset:2560
  v_mfma_f32_32x32x16_bf16 v[32:47], v[144:147], v[140:143], v[32:47]
  ds_read_b128 v[124:127], v166 offset:0
  ds_read_b128 v[128:131], v166 offset:4096
  s_waitcnt lgkmcnt(4)
  v_mfma_f32_32x32x16_bf16 v[16:31], v[120:123], v[112:115], v[16:31]
  ds_read_b64_tr_b16 v[144:145], v164 offset:4096
  ds_read_b64_tr_b16 v[146:147], v164 offset:4608
  v_mfma_f32_32x32x16_bf16 v[32:47], v[120:123], v[116:119], v[32:47]
  ds_read_b128 v[136:139], v167 offset:0
  ds_read_b128 v[140:143], v167 offset:4096
  s_waitcnt lgkmcnt(4)
  v_mfma_f32_32x32x16_bf16 v[16:31], v[132:135], v[124:127], v[16:31]
  ds_read_b64_tr_b16 v[120:121], v164 offset:6144
  ds_read_b64_tr_b16 v[122:123], v164 offset:6656
  v_mfma_f32_32x32x16_bf16 v[32:47], v[132:135], v[128:131], v[32:47]
  ds_read_b128 v[112:115], v168 offset:0
  ds_read_b128 v[116:119], v168 offset:4096
  s_waitcnt lgkmcnt(0)
  s_barrier
  v_mfma_f32_32x32x16_bf16 v[16:31], v[144:147], v[136:139], v[16:31]
  ds_read_b64_tr_b16 v[132:133], v164 offset:8192
  ds_read_b64_tr_b16 v[134:135], v164 offset:8704
  v_mfma_f32_32x32x16_bf16 v[32:47], v[144:147], v[140:143], v[32:47]
  ds_read_b128 v[124:127], v165 offset:16384
  ds_read_b128 v[128:131], v165 offset:20480
  s_waitcnt lgkmcnt(4)
  v_mfma_f32_32x32x16_bf16 v[16:31], v[120:123], v[112:115], v[16:31]
  ds_read_b64_tr_b16 v[144:145], v164 offset:10240
  ds_read_b64_tr_b16 v[146:147], v164 offset:10752
  v_mfma_f32_32x32x16_bf16 v[32:47], v[120:123], v[116:119], v[32:47]
  ds_read_b128 v[136:139], v166 offset:16384
  ds_read_b128 v[140:143], v166 offset:20480
  s_waitcnt lgkmcnt(4)
  v_mfma_f32_32x32x16_bf16 v[16:31], v[132:135], v[124:127], v[16:31]
  ds_read_b64_tr_b16 v[120:121], v164 offset:12288
  ds_read_b64_tr_b16 v[122:123], v164 offset:12800
  v_mfma_f32_32x32x16_bf16 v[32:47], v[132:135], v[128:131], v[32:47]
  ds_read_b128 v[112:115], v167 offset:16384
  ds_read_b128 v[116:119], v167 offset:20480
  s_waitcnt lgkmcnt(4)
  v_mfma_f32_32x32x16_bf16 v[16:31], v[144:147], v[136:139], v[16:31]
  ds_read_b64_tr_b16 v[132:133], v164 offset:14336
  ds_read_b64_tr_b16 v[134:135], v164 offset:14848
  v_mfma_f32_32x32x16_bf16 v[32:47], v[144:147], v[140:143], v[32:47]
  ds_read_b128 v[124:127], v168 offset:16384
  ds_read_b128 v[128:131], v168 offset:20480
  s_waitcnt lgkmcnt(4)
  v_mfma_f32_32x32x16_bf16 v[16:31], v[120:123], v[112:115], v[16:31]
  ds_read_b64_tr_b16 v[144:145], v164 offset:16384
  ds_read_b64_tr_b16 v[146:147], v164 offset:16896
  v_mfma_f32_32x32x16_bf16 v[32:47], v[120:123], v[116:119], v[32:47]
  ds_read_b128 v[136:139], v165 offset:32768
  ds_read_b128 v[140:143], v165 offset:36864
  s_waitcnt lgkmcnt(4)
  v_mfma_f32_32x32x16_bf16 v[16:31], v[132:135], v[124:127], v[16:31]
  ds_read_b64_tr_b16 v[120:121], v164 offset:18432
  ds_read_b64_tr_b16 v[122:123], v164 offset:18944
  v_mfma_f32_32x32x16_bf16 v[32:47], v[132:135], v[128:131], v[32:47]
  ds_read_b128 v[112:115], v166 offset:32768
  ds_read_b128 v[116:119], v166 offset:36864
  s_waitcnt lgkmcnt(4)
  v_mfma_f32_32x32x16_bf16 v[16:31], v[144:147], v[136:139], v[16:31]
  ds_read_b64_tr_b16 v[132:133], v164 offset:20480
  ds_read_b64_tr_b16 v[134:135], v164 offset:20992
  v_mfma_f32_32x32x16_bf16 v[32:47], v[144:147], v[140:143], v[32:47]
  ds_read_b128 v[124:127], v167 offset:32768
  ds_read_b128 v[128:131], v167 offset:36864
  s_waitcnt lgkmcnt(4)
  v_mfma_f32_32x32x16_bf16 v[16:31], v[120:123], v[112:115], v[16:31]
  ds_read_b64_tr_b16 v[144:145], v164 offset:22528
  ds_read_b64_tr_b16 v[146:147], v164 offset:23040
  v_mfma_f32_32x32x16_bf16 v[32:47], v[120:123], v[116:119], v[32:47]
  ds_read_b128 v[136:139], v168 offset:32768
  ds_read_b128 v[140:143], v168 offset:36864
  s_waitcnt lgkmcnt(4)
  v_mfma_f32_32x32x16_bf16 v[16:31], v[132:135], v[124:127], v[16:31]
  v_mfma_f32_32x32x16_bf16 v[32:47], v[132:135], v[128:131], v[32:47]
  s_waitcnt lgkmcnt(0)
  v_mfma_f32_32x32x16_bf16 v[16:31], v[144:147], v[136:139], v[16:31]
  v_mfma_f32_32x32x16_bf16 v[32:47], v[144:147], v[140:143], v[32:47]
  s_lshl_b32 s62, s28, 3
  s_add_u32 s62, s62, s54
  s_lshl_b32 s62, s62, 4
  s_add_u32 s62, s62, s58
  s_lshl_b32 s62, s62, 7
  s_add_u32 s63, s62, 17891328
  s_add_u32 s62, s62, 17825792
  s_waitcnt vmcnt(0)
  v_readfirstlane_b32 s50, v156
  v_readfirstlane_b32 s51, v157
  s_mov_b32 s52, 20000
LN7:
  s_cmp_lg_u32 s50, 0
  s_cbranch_scc1 LN8
  s_sub_u32 s52, s52, 1
  s_cmp_eq_u32 s52, 0
  s_cbranch_scc1 LN8
  buffer_load_dwordx2 v[156:157], v9, s[44:47], 0 offen sc1
  s_waitcnt vmcnt(0)
  v_readfirstlane_b32 s50, v156
  v_readfirstlane_b32 s51, v157
  s_branch LN7
LN8:
  s_barrier
  s_cmp_lg_u32 s31, 0
  s_cbranch_scc1 LE6
  v_mov_b32 v14, s50
  v_mov_b32 v15, s51
  s_mov_b64 exec, 1
  buffer_store_dwordx2 v[14:15], v9, s[24:27], s63 offen sc0 sc1
  s_mov_b64 exec, -1
LE6:
  s_nop 3
  v_fma_f32 v176, v16, s34, v170
  v_fma_f32 v177, v17, s34, v170
  v_fma_f32 v178, v18, s34, v170
  v_fma_f32 v179, v19, s34, v170
  v_fma_f32 v180, v20, s34, v170
  v_fma_f32 v181, v21, s34, v170
  v_fma_f32 v182, v22, s34, v170
  v_fma_f32 v183, v23, s34, v170
  v_fma_f32 v184, v24, s34, v170
  v_fma_f32 v185, v25, s34, v170
  v_fma_f32 v186, v26, s34, v170
  v_fma_f32 v187, v27, s34, v170
  v_fma_f32 v188, v28, s34, v170
  v_fma_f32 v189, v29, s34, v170
  v_fma_f32 v190, v30, s34, v170
  v_fma_f32 v191, v31, s34, v170
  v_exp_f32 v176, v176 clamp
  v_max_f32 v16, v16, v171
  v_exp_f32 v177, v177 clamp
  v_max_f32 v17, v17, v171
  v_exp_f32 v178, v178 clamp
  v_max_f32 v18, v18, v171
  v_exp_f32 v179, v179 clamp
  v_max_f32 v19, v19, v171
  v_exp_f32 v180, v180 clamp
  v_max_f32 v20, v20, v171
  v_exp_f32 v181, v181 clamp
  v_max_f32 v21, v21, v171
  v_exp_f32 v182, v182 clamp
  v_max_f32 v22, v22, v171
  v_exp_f32 v183, v183 clamp
  v_max_f32 v23, v23, v171
  v_exp_f32 v184, v184 clamp
  v_max_f32 v24, v24, v171
  v_exp_f32 v185, v185 clamp
  v_max_f32 v25, v25, v171
  v_exp_f32 v186, v186 clamp
  v_max_f32 v26, v26, v171
  v_exp_f32 v187, v187 clamp
  v_max_f32 v27, v27, v171
  v_exp_f32 v188, v188 clamp
  v_max_f32 v28, v28, v171
  v_exp_f32 v189, v189 clamp
  v_max_f32 v29, v29, v171
  v_exp_f32 v190, v190 clamp
  v_max_f32 v30, v30, v171
  v_exp_f32 v191, v191 clamp
  v_max_f32 v31, v31, v171
  v_add_f32 v16, v16, v176
  v_add_f32 v17, v17, v177
  v_add_f32 v18, v18, v178
  v_add_f32 v19, v19, v179
  v_add_f32 v20, v20, v180
  v_add_f32 v21, v21, v181
  v_add_f32 v22, v22, v182
  v_add_f32 v23, v23, v183
  v_add_f32 v24, v24, v184
  v_add_f32 v25, v25, v185
  v_add_f32 v26, v26, v186
  v_add_f32 v27, v27, v187
  v_add_f32 v28, v28, v188
  v_add_f32 v29, v29, v189
  v_add_f32 v30, v30, v190
  v_add_f32 v31, v31, v191
  v_cvt_pk_bf16_f32 v192, v16, v17
  v_cvt_pk_bf16_f32 v193, v18, v19
  v_cvt_pk_bf16_f32 v194, v20, v21
  v_cvt_pk_bf16_f32 v195, v22, v23
  v_cvt_pk_bf16_f32 v196, v24, v25
  v_cvt_pk_bf16_f32 v197, v26, v27
  v_cvt_pk_bf16_f32 v198, v28, v29
  v_cvt_pk_bf16_f32 v199, v30, v31
  s_nop 0
  v_permlane32_swap_b32 v192, v194
  v_permlane32_swap_b32 v193, v195
  v_permlane32_swap_b32 v196, v198
  v_permlane32_swap_b32 v197, v199
  buffer_store_dwordx4 v[192:195], v8, s[24:27], s37 offen offset:0 sc1
  buffer_store_dwordx4 v[196:199], v8, s[24:27], s37 offen offset:1024 sc1
  s_add_u32 s37, s37, 28672
  v_fma_f32 v176, v32, s34, v170
  v_fma_f32 v177, v33, s34, v170
  v_fma_f32 v178, v34, s34, v170
  v_fma_f32 v179, v35, s34, v170
  v_fma_f32 v180, v36, s34, v170
  v_fma_f32 v181, v37, s34, v170
  v_fma_f32 v182, v38, s34, v170
  v_fma_f32 v183, v39, s34, v170
  v_fma_f32 v184, v40, s34, v170
  v_fma_f32 v185, v41, s34, v170
  v_fma_f32 v186, v42, s34, v170
  v_fma_f32 v187, v43, s34, v170
  v_fma_f32 v188, v44, s34, v170
  v_fma_f32 v189, v45, s34, v170
  v_fma_f32 v190, v46, s34, v170
  v_fma_f32 v191, v47, s34, v170
  v_exp_f32 v176, v176 clamp
  v_max_f32 v32, v32, v171
  v_exp_f32 v177, v177 clamp
  v_max_f32 v33, v33, v171
  v_exp_f32 v178, v178 clamp
  v_max_f32 v34, v34, v171
  v_exp_f32 v179, v179 clamp
  v_max_f32 v35, v35, v171
  v_exp_f32 v180, v180 clamp
  v_max_f32 v36, v36, v171
  v_exp_f32 v181, v181 clamp
  v_max_f32 v37, v37, v171
  v_exp_f32 v182, v182 clamp
  v_max_f32 v38, v38, v171
  v_exp_f32 v183, v183 clamp
  v_max_f32 v39, v39, v171
  v_exp_f32 v184, v184 clamp
  v_max_f32 v40, v40, v171
  v_exp_f32 v185, v185 clamp
  v_max_f32 v41, v41, v171
  v_exp_f32 v186, v186 clamp
  v_max_f32 v42, v42, v171
  v_exp_f32 v187, v187 clamp
  v_max_f32 v43, v43, v171
  v_exp_f32 v188, v188 clamp
  v_max_f32 v44, v44, v171
  v_exp_f32 v189, v189 clamp
  v_max_f32 v45, v45, v171
  v_exp_f32 v190, v190 clamp
  v_max_f32 v46, v46, v171
  v_exp_f32 v191, v191 clamp
  v_max_f32 v47, v47, v171
  v_add_f32 v32, v32, v176
  v_add_f32 v33, v33, v177
  v_add_f32 v34, v34, v178
  v_add_f32 v35, v35, v179
  v_add_f32 v36, v36, v180
  v_add_f32 v37, v37, v181
  v_add_f32 v38, v38, v182
  v_add_f32 v39, v39, v183
  v_add_f32 v40, v40, v184
  v_add_f32 v41, v41, v185
  v_add_f32 v42, v42, v186
  v_add_f32 v43, v43, v187
  v_add_f32 v44, v44, v188
  v_add_f32 v45, v45, v189
  v_add_f32 v46, v46, v190
  v_add_f32 v47, v47, v191
  v_cvt_pk_bf16_f32 v200, v32, v33
  v_cvt_pk_bf16_f32 v201, v34, v35
  v_cvt_pk_bf16_f32 v202, v36, v37
  v_cvt_pk_bf16_f32 v203, v38, v39
  v_cvt_pk_bf16_f32 v204, v40, v41
  v_cvt_pk_bf16_f32 v205, v42, v43
  v_cvt_pk_bf16_f32 v206, v44, v45
  v_cvt_pk_bf16_f32 v207, v46, v47
  s_nop 0
  v_permlane32_swap_b32 v200, v202
  v_permlane32_swap_b32 v201, v203
  v_permlane32_swap_b32 v204, v206
  v_permlane32_swap_b32 v205, v207
  buffer_store_dwordx4 v[200:203], v8, s[24:27], s37 offen offset:0 sc1
  buffer_store_dwordx4 v[204:207], v8, s[24:27], s37 offen offset:1024 sc1
  s_add_u32 s37, s37, 28672
L_PE:
  s_waitcnt vmcnt(0)
  s_lshl_b32 s35, s31, 2
  v_mov_b32 v10, 0
  v_add_u32 v11, s35, v10
  v_mov_b32 v14, s50
  ds_write_b32 v11, v14
  s_waitcnt lgkmcnt(0)
  ds_read_b128 v[16:19], v10
  s_waitcnt lgkmcnt(0)
  v_xor_b32 v16, v16, v14
  v_xor_b32 v17, v17, v14
  v_xor_b32 v18, v18, v14
  v_xor_b32 v19, v19, v14
  v_or3_b32 v16, v16, v17, v18
  v_or_b32 v16, v16, v19
  s_nop 0
  v_readfirstlane_b32 s35, v16
  s_nop 0
  s_cmp_lg_u32 s35, 0
  s_cbranch_scc1 LF9
  v_mov_b32 v14, s50
  v_mov_b32 v15, s51
  s_mov_b64 exec, 1
  buffer_store_dwordx2 v[14:15], v9, s[24:27], s62 offen sc0 sc1
  s_mov_b64 exec, -1
LF9:
  s_branch L_ATT
L_IDLE:
  s_sub_u32 s34, s30, 28
  s_lshl_b32 s34, s34, 3
  s_add_u32 s34, s34, s31
  s_getpc_b64 s[38:39]
L_PC:
  s_sub_u32 s38, s38, L_PC-concat_heads__softmax_full_mha__linear_attn_block__prompt_kernel
  s_subb_u32 s39, s39, 0
  s_lshl_b32 s35, s34, 10
  v_add_u32 v16, s35, v8
  v_min_u32 v17, L_CEND-concat_heads__softmax_full_mha__linear_attn_block__prompt_kernel-16, v16
  v_mov_b32 v19, s39
  v_add_co_u32 v18, vcc, s38, v17
  s_nop 1
  v_addc_co_u32 v19, vcc, 0, v19, vcc
  global_load_dwordx4 v[24:27], v[18:19], off
  v_add_u32 v16, 32768, v16
  v_min_u32 v17, L_CEND-concat_heads__softmax_full_mha__linear_attn_block__prompt_kernel-16, v16
  v_mov_b32 v19, s39
  v_add_co_u32 v18, vcc, s38, v17
  s_nop 1
  v_addc_co_u32 v19, vcc, 0, v19, vcc
  global_load_dwordx4 v[28:31], v[18:19], off
  v_add_u32 v16, 32768, v16
  buffer_load_dwordx2 v[156:157], v9, s[44:47], 0 offen sc1
  s_mul_i32 s34, s34, 13312
  s_mov_b32 s16, s8
  s_and_b32 s17, s9, 0xffff
  s_mov_b32 s18, 401408
  s_mov_b32 s19, 0x20000
  s_mov_b32 s20, s14
  s_and_b32 s21, s15, 0xffff
  s_mov_b32 s22, 401408
  s_mov_b32 s23, 0x20000
  buffer_load_dwordx4 v[16:19], v8, s[16:19], s34 offen
  buffer_load_dwordx4 v[20:23], v8, s[20:23], s34 offen
  s_add_u32 s34, s34, 1024
  buffer_load_dwordx4 v[16:19], v8, s[16:19], s34 offen
  buffer_load_dwordx4 v[20:23], v8, s[20:23], s34 offen
  s_add_u32 s34, s34, 1024
  buffer_load_dwordx4 v[16:19], v8, s[16:19], s34 offen
  buffer_load_dwordx4 v[20:23], v8, s[20:23], s34 offen
  s_add_u32 s34, s34, 1024
  buffer_load_dwordx4 v[16:19], v8, s[16:19], s34 offen
  buffer_load_dwordx4 v[20:23], v8, s[20:23], s34 offen
  s_add_u32 s34, s34, 1024
  buffer_load_dwordx4 v[16:19], v8, s[16:19], s34 offen
  buffer_load_dwordx4 v[20:23], v8, s[20:23], s34 offen
  s_add_u32 s34, s34, 1024
  buffer_load_dwordx4 v[16:19], v8, s[16:19], s34 offen
  buffer_load_dwordx4 v[20:23], v8, s[20:23], s34 offen
  s_add_u32 s34, s34, 1024
  buffer_load_dwordx4 v[16:19], v8, s[16:19], s34 offen
  buffer_load_dwordx4 v[20:23], v8, s[20:23], s34 offen
  s_add_u32 s34, s34, 1024
  buffer_load_dwordx4 v[16:19], v8, s[16:19], s34 offen
  buffer_load_dwordx4 v[20:23], v8, s[20:23], s34 offen
  s_add_u32 s34, s34, 1024
  buffer_load_dwordx4 v[16:19], v8, s[16:19], s34 offen
  buffer_load_dwordx4 v[20:23], v8, s[20:23], s34 offen
  s_add_u32 s34, s34, 1024
  buffer_load_dwordx4 v[16:19], v8, s[16:19], s34 offen
  buffer_load_dwordx4 v[20:23], v8, s[20:23], s34 offen
  s_add_u32 s34, s34, 1024
  buffer_load_dwordx4 v[16:19], v8, s[16:19], s34 offen
  buffer_load_dwordx4 v[20:23], v8, s[20:23], s34 offen
  s_add_u32 s34, s34, 1024
  buffer_load_dwordx4 v[16:19], v8, s[16:19], s34 offen
  buffer_load_dwordx4 v[20:23], v8, s[20:23], s34 offen
  s_add_u32 s34, s34, 1024
  buffer_load_dwordx4 v[16:19], v8, s[16:19], s34 offen
  buffer_load_dwordx4 v[20:23], v8, s[20:23], s34 offen
  s_add_u32 s34, s34, 1024
  s_waitcnt vmcnt(0)
  v_readfirstlane_b32 s50, v156
  v_readfirstlane_b32 s51, v157
  s_mov_b32 s52, 20000
LN10:
  s_cmp_lg_u32 s50, 0
  s_cbranch_scc1 LN11
  s_sub_u32 s52, s52, 1
  s_cmp_eq_u32 s52, 0
  s_cbranch_scc1 LN11
  buffer_load_dwordx2 v[156:157], v9, s[44:47], 0 offen sc1
  s_waitcnt vmcnt(0)
  v_readfirstlane_b32 s50, v156
  v_readfirstlane_b32 s51, v157
  s_branch LN10
LN11:
L_ATT:
  s_setprio 3
  s_mov_b32 s16, s8
  s_and_b32 s17, s9, 0xffff
  s_mov_b32 s18, 401408
  s_mov_b32 s19, 0x20000
  s_mov_b32 s20, s14
  s_and_b32 s21, s15, 0xffff
  s_mov_b32 s22, 401408
  s_mov_b32 s23, 0x20000
  s_cmp_eq_u32 s31, 7
  s_cselect_b64 vcc, -1, 0
  v_and_b32 v2, 1, v1
  v_lshlrev_b32 v2, 4, v2
  s_lshl_b32 s34, s56, 7
  s_add_u32 s34, s34, 4294901760
  v_readlane_b32 s35, v158, 0
  v_readlane_b32 s33, v158, 16
  s_nop 0
  s_sub_u32 s33, s33, s35
  s_add_u32 s34, s34, s35
  v_lshrrev_b32 v2, 4, v2
  v_mul_u32_u24 v2, s33, v2
  v_add_u32 v2, s34, v2
  s_cbranch_vccz LS12
  s_mul_i32 s33, s55, 7
  s_lshr_b32 s34, s33, 4
  s_add_u32 s34, s34, 448
  v_and_b32 v3, 19, v1
  v_bfe_u32 v2, v1, 2, 1
  v_lshl_add_u32 v3, v2, 3, v3
  v_bfe_u32 v2, v1, 3, 1
  v_lshl_add_u32 v3, v2, 2, v3
  v_lshrrev_b32 v5, 5, v1
  v_mul_u32_u24 v6, 7168, v5
  v_lshl_add_u32 v3, v3, 4, v6
  v_lshl_add_u32 v6, v5, 7, v6
  v_and_b32 v5, 31, v1
  v_add_u32 v7, 20, v5
  v_lshrrev_b32 v7, 5, v7
  v_sub_u32 v2, v5, v7
  v_lshrrev_b32 v7, 4, v5
  v_sub_u32 v2, v2, v7
  v_add_u32 v7, 4, v5
  v_lshrrev_b32 v7, 5, v7
  v_sub_u32 v2, v2, v7
  s_lshl_b32 s33, s33, 2
  v_add_u32 v2, s33, v2
  v_and_b32 v5, 11, v5
  v_cmp_eq_u32 s[48:49], 11, v5
  v_mov_b32 v7, s34
  s_nop 0
  v_cndmask_b32 v2, v2, v7, s[48:49]
  v_lshl_add_u32 v2, v2, 4, v6
LS12:
  s_lshl_b32 s34, s56, 2
  s_lshl_b32 s35, s61, 1
  s_add_u32 s34, s34, s35
  s_lshr_b32 s35, s60, 1
  s_add_u32 s34, s34, s35
  s_lshl_b32 s34, s34, 4
  s_add_u32 s34, s34, s55
  s_lshl_b32 s34, s34, 1
  s_and_b32 s35, s60, 1
  s_add_u32 s34, s34, s35
  s_lshl_b32 s34, s34, 10
  s_add_u32 s59, s34, 12582912
  s_lshl_b32 s34, s56, 2
  s_add_u32 s34, s34, s60
  s_lshl_b32 s34, s34, 4
  s_add_u32 s34, s34, s55
  s_lshl_b32 s34, s34, 11
  s_add_u32 s34, s34, 14680064
  s_cmp_lt_u32 s31, 4
  s_cselect_b32 s58, s34, 18874368
  v_and_b32 v5, 31, v1
  v_add_u32 v7, 20, v5
  v_lshrrev_b32 v7, 5, v7
  v_sub_u32 v6, v5, v7
  v_lshrrev_b32 v7, 4, v5
  v_sub_u32 v6, v6, v7
  v_add_u32 v7, 4, v5
  v_lshrrev_b32 v7, 5, v7
  v_sub_u32 v6, v6, v7
  v_and_b32 v5, 11, v5
  v_cmp_eq_u32 s[48:49], 11, v5
  v_lshrrev_b32 v5, 5, v1
  v_lshlrev_b32 v5, 9, v5
  v_cndmask_b32 v6, v6, 28, s[48:49]
  v_lshl_add_u32 v5, v6, 4, v5
  s_mul_i32 s33, s55, 7
  s_lshr_b32 s34, s33, 3
  s_add_u32 s35, s33, 6
  s_lshr_b32 s35, s35, 3
  s_lshl_b32 s34, s34, 8
  s_lshl_b32 s35, s35, 8
  s_add_u32 s34, s34, 16908288
  s_add_u32 s35, s35, 16908288
  s_lshl_b32 s37, s56, 4
  v_and_b32 v12, 12, v13
  v_add_u32 v12, s37, v12
  s_lshl_b32 s37, s56, 2
  s_lshl_b32 s38, s61, 1
  s_add_u32 s37, s37, s38
  s_lshl_b32 s37, s37, 15
  s_add_u32 s37, s37, s29
  s_add_u32 s38, s37, 32768
  s_cbranch_vccnz L_P7
  s_cmp_lg_u32 s31, 6
  s_cbranch_scc1 L_B1
L_P7:
  s_mov_b32 exec_hi, vcc_hi
  buffer_load_dwordx2 v[10:11], v158, s[24:27], 0 offen sc0 sc1
  s_mov_b32 s52, 20000
L_PL:
  s_waitcnt vmcnt(0)
  v_cmp_ne_u64 s[48:49], s[50:51], v[10:11]
  s_nop 0
  s_cmp_eq_u64 s[48:49], 0
  s_cbranch_scc1 L_PD
  s_sleep 4
  buffer_load_dwordx2 v[10:11], v158, s[24:27], 0 offen sc0 sc1
  s_sub_u32 s52, s52, 1
  s_cbranch_scc0 L_PL
L_PD:
  s_mov_b64 exec, -1
  s_cbranch_vccz L_B1
  s_mov_b64 s[62:63], s[34:35]
  s_mul_i32 s34, s56, 114688
  s_lshr_b32 s35, s29, 2
  s_add_u32 s34, s34, s35
  s_add_u32 s34, s34, 8388608
  s_mul_i32 s35, s56, 116736
  s_add_u32 s35, s35, 10485760
  buffer_load_dwordx4 v[32:35], v3, s[24:27], s34 offen sc1
  buffer_load_dwordx4 v[144:147], v2, s[24:27], s35 offen sc1
  s_add_u32 s34, s34, 14336
  s_add_u32 s35, s35, 14592
  buffer_load_dwordx4 v[36:39], v3, s[24:27], s34 offen sc1
  buffer_load_dwordx4 v[148:151], v2, s[24:27], s35 offen sc1
  s_add_u32 s34, s34, 14336
  s_add_u32 s35, s35, 14592
  buffer_load_dwordx4 v[40:43], v3, s[24:27], s34 offen sc1
  buffer_load_dwordx4 v[152:155], v2, s[24:27], s35 offen sc1
  s_add_u32 s34, s34, 14336
  s_add_u32 s35, s35, 14592
  buffer_load_dwordx4 v[44:47], v3, s[24:27], s34 offen sc1
  buffer_load_dwordx4 v[156:159], v2, s[24:27], s35 offen sc1
  s_add_u32 s34, s34, 14336
  s_add_u32 s35, s35, 14592
  buffer_load_dwordx4 v[48:51], v3, s[24:27], s34 offen sc1
  buffer_load_dwordx4 v[160:163], v2, s[24:27], s35 offen sc1
  s_add_u32 s34, s34, 14336
  s_add_u32 s35, s35, 14592
  buffer_load_dwordx4 v[52:55], v3, s[24:27], s34 offen sc1
  buffer_load_dwordx4 v[164:167], v2, s[24:27], s35 offen sc1
  s_add_u32 s34, s34, 14336
  s_add_u32 s35, s35, 14592
  buffer_load_dwordx4 v[56:59], v3, s[24:27], s34 offen sc1
  buffer_load_dwordx4 v[168:171], v2, s[24:27], s35 offen sc1
  s_add_u32 s34, s34, 14336
  s_add_u32 s35, s35, 14592
  buffer_load_dwordx4 v[60:63], v3, s[24:27], s34 offen sc1
  buffer_load_dwordx4 v[172:175], v2, s[24:27], s35 offen sc1
  s_mov_b64 s[34:35], s[62:63]
L_B1:
  s_barrier
  s_cmp_lg_u32 s31, 6
  s_cbranch_scc1 L_NQ
  buffer_load_dwordx2 v[6:7], v2, s[24:27], 0 offen sc0 sc1
L_NQ:
  buffer_load_dword v10, v13, s[24:27], s34 offen offset:3584 sc1
  buffer_load_dword v11, v13, s[24:27], s35 offen offset:3584 sc1
  s_xor_b32 s42, s70, 0
  buffer_load_dwordx4 v[192:195], v8, s[24:27], s42 offen offset:0 sc1
  buffer_load_dwordx4 v[196:199], v8, s[24:27], s42 offen offset:1024 sc1
  s_xor_b32 s42, s70, 32768
  buffer_load_dwordx4 v[208:211], v8, s[24:27], s42 offen offset:0 sc1
  buffer_load_dwordx4 v[212:215], v8, s[24:27], s42 offen offset:1024 sc1
  s_xor_b32 s42, s71, 0
  buffer_load_dwordx4 v[200:203], v5, s[24:27], s42 offen offset:0 sc1
  buffer_load_dwordx4 v[204:207], v5, s[24:27], s42 offen offset:1024 sc1
  s_xor_b32 s42, s71, 2048
  buffer_load_dwordx4 v[216:219], v5, s[24:27], s42 offen offset:0 sc1
  buffer_load_dwordx4 v[220:223], v5, s[24:27], s42 offen offset:1024 sc1
  s_xor_b32 s42, s70, 65536
  buffer_load_dwordx4 v[224:227], v8, s[24:27], s42 offen offset:0 sc1
  buffer_load_dwordx4 v[228:231], v8, s[24:27], s42 offen offset:1024 sc1
  s_xor_b32 s42, s70, 98304
  buffer_load_dwordx4 v[240:243], v8, s[24:27], s42 offen offset:0 sc1
  buffer_load_dwordx4 v[244:247], v8, s[24:27], s42 offen offset:1024 sc1
  s_cbranch_vccz LS13
  s_waitcnt vmcnt(14)
  v_mfma_f32_32x32x16_bf16 v[176:191], v[32:35], v[144:147], 0
  v_mfma_f32_32x32x16_bf16 v[176:191], v[36:39], v[148:151], v[176:191]
  v_mfma_f32_32x32x16_bf16 v[176:191], v[40:43], v[152:155], v[176:191]
  v_mfma_f32_32x32x16_bf16 v[176:191], v[44:47], v[156:159], v[176:191]
  v_mfma_f32_32x32x16_bf16 v[176:191], v[48:51], v[160:163], v[176:191]
  v_mfma_f32_32x32x16_bf16 v[176:191], v[52:55], v[164:167], v[176:191]
  v_mfma_f32_32x32x16_bf16 v[176:191], v[56:59], v[168:171], v[176:191]
  v_mfma_f32_32x32x16_bf16 v[176:191], v[60:63], v[172:175], v[176:191]
  s_nop 15
  s_nop 3
LS13:
  s_cbranch_vccz LS14
  s_lshl_b32 s42, s55, 12
  s_add_u32 s42, s42, 16777216
  buffer_atomic_add_f32 v176, v13, s[24:27], s42 offen offset:0
  buffer_atomic_add_f32 v177, v13, s[24:27], s42 offen offset:256
  buffer_atomic_add_f32 v178, v13, s[24:27], s42 offen offset:512
  buffer_atomic_add_f32 v179, v13, s[24:27], s42 offen offset:768
  buffer_atomic_add_f32 v180, v13, s[24:27], s42 offen offset:1024
  buffer_atomic_add_f32 v181, v13, s[24:27], s42 offen offset:1280
  buffer_atomic_add_f32 v182, v13, s[24:27], s42 offen offset:1536
  buffer_atomic_add_f32 v183, v13, s[24:27], s42 offen offset:1792
  buffer_atomic_add_f32 v184, v13, s[24:27], s42 offen offset:2048
  buffer_atomic_add_f32 v185, v13, s[24:27], s42 offen offset:2304
  buffer_atomic_add_f32 v186, v13, s[24:27], s42 offen offset:2560
  buffer_atomic_add_f32 v187, v13, s[24:27], s42 offen offset:2816
  buffer_atomic_add_f32 v188, v13, s[24:27], s42 offen offset:3072
  buffer_atomic_add_f32 v189, v13, s[24:27], s42 offen offset:3328
  buffer_atomic_add_f32 v190, v13, s[24:27], s42 offen offset:3584
  buffer_atomic_add_f32 v191, v13, s[24:27], s42 offen offset:3840
LS14:
  s_cmp_lg_u32 s31, 6
  s_cbranch_scc1 L_B2
  s_waitcnt vmcnt(14)
  s_mov_b32 s52, 20000
  s_branch L_QE
L_QL:
  s_waitcnt vmcnt(0)
L_QE:
  v_cmp_ne_u64 s[48:49], s[50:51], v[6:7]
  s_nop 0
  s_cmp_eq_u64 s[48:49], 0
  s_cbranch_scc1 L_B2
  s_sleep 1
  buffer_load_dwordx2 v[6:7], v2, s[24:27], 0 offen sc0 sc1
  s_sub_u32 s52, s52, 1
  s_cbranch_scc0 L_QL
L_B2:
  s_barrier
  buffer_load_dword v14, v12, s[24:27], s34 offen sc1
  buffer_load_dword v15, v12, s[24:27], s35 offen sc1
  buffer_load_dwordx4 v[16:19], v8, s[24:27], s37 offen offset:0 sc1
  buffer_load_dwordx4 v[20:23], v8, s[24:27], s37 offen offset:1024 sc1
  buffer_load_dwordx4 v[24:27], v8, s[24:27], s38 offen offset:0 sc1
  buffer_load_dwordx4 v[28:31], v8, s[24:27], s38 offen offset:1024 sc1
  v_mov_b32 v36, 0
  v_mov_b32 v37, 0
  v_mov_b32 v38, 0
  v_mov_b32 v39, 0
  s_bitcmp1_b32 s55, 0
  s_cselect_b32 s38, -1, 0
  s_mov_b32 s39, 0
  s_mov_b32 s40, 0
  s_cselect_b32 s41, 0, -1
  s_waitcnt vmcnt(34)
  s_cbranch_vccnz LW15
  s_waitcnt vmcnt(18)
LW15:
  v_add_f32 v10, v10, v11
  s_nop 1
  v_max_f32_dpp v10, v10, v10 quad_perm:[1,0,3,2] row_mask:0xf bank_mask:0xf
  s_nop 1
  v_max_f32_dpp v10, v10, v10 quad_perm:[2,3,0,1] row_mask:0xf bank_mask:0xf
  s_nop 1
  v_max_f32_dpp v10, v10, v10 row_half_mirror row_mask:0xf bank_mask:0xf
  s_nop 1
  v_max_f32_dpp v10, v10, v10 row_mirror row_mask:0xf bank_mask:0xf
  s_nop 1
  v_readlane_b32 s32, v10, 0
  v_readlane_b32 s33, v10, 16
  v_readlane_b32 s42, v10, 32
  v_readlane_b32 s43, v10, 48
  s_nop 1
  s_max_u32 s32, s32, s33
  s_max_u32 s42, s42, s43
  s_max_u32 s32, s32, s42
  s_waitcnt vmcnt(4)
  s_cbranch_vccz LS16
  s_lshl_b32 s42, s55, 7
  s_add_u32 s42, s42, 16842752
  v_mov_b32 v7, 1
  s_mov_b64 exec, 1
  buffer_atomic_add v7, v9, s[24:27], s42 offen
  s_mov_b64 exec, -1
LS16:
  v_add_f32 v14, v14, v15
  s_nop 1
  v_max_f32_dpp v14, v14, v14 quad_perm:[1,0,3,2] row_mask:0xf bank_mask:0xf
  s_nop 1
  v_max_f32_dpp v14, v14, v14 quad_perm:[2,3,0,1] row_mask:0xf bank_mask:0xf
  s_nop 1
  v_mul_f32 v14, s32, v14
  s_nop 0
  v_readfirstlane_b32 s32, v14
  s_nop 1
  s_waitcnt vmcnt(1)
  s_cbranch_vccnz LW17
  s_waitcnt vmcnt(0)
LW17:
  v_cndmask_b32 v16, v16, 0, s[38:39]
  v_cndmask_b32 v17, v17, 0, s[38:39]
  v_cndmask_b32 v22, v22, 0, s[40:41]
  v_cndmask_b32 v23, v23, 0, s[40:41]
  v_cndmask_b32 v24, v24, 0, s[38:39]
  v_cndmask_b32 v25, v25, 0, s[38:39]
  v_cndmask_b32 v30, v30, 0, s[40:41]
  v_cndmask_b32 v31, v31, 0, s[40:41]
  s_cmp_le_u32 s32, 1163984896
  s_cbranch_scc0 L_SLOW
  s_setprio 3
  v_mfma_f32_32x32x16_bf16 v[96:111], v[192:195], v[16:19], 0
  v_mfma_f32_32x32x16_bf16 v[96:111], v[196:199], v[20:23], v[96:111]
  s_nop 11
  v_exp_f32 v96, v96
  v_mfma_f32_32x32x16_bf16 v[112:127], v[192:195], v[24:27], 0
  v_exp_f32 v97, v97
  v_exp_f32 v98, v98
  v_cvt_pk_bf16_f32 v128, v96, v97
  v_exp_f32 v99, v99
  v_mfma_f32_32x32x16_bf16 v[112:127], v[196:199], v[28:31], v[112:127]
  v_exp_f32 v100, v100
  v_cvt_pk_bf16_f32 v129, v98, v99
  v_exp_f32 v101, v101
  v_exp_f32 v102, v102
  v_cvt_pk_bf16_f32 v130, v100, v101
  v_exp_f32 v103, v103
  s_xor_b32 s42, s71, 4096
  buffer_load_dwordx4 v[232:235], v5, s[24:27], s42 offen offset:0 sc1
  buffer_load_dwordx4 v[236:239], v5, s[24:27], s42 offen offset:1024 sc1
  v_exp_f32 v104, v104
  v_cvt_pk_bf16_f32 v131, v102, v103
  v_exp_f32 v105, v105
  v_exp_f32 v106, v106
  v_cvt_pk_bf16_f32 v132, v104, v105
  v_exp_f32 v107, v107
  v_exp_f32 v108, v108
  v_cvt_pk_bf16_f32 v133, v106, v107
  v_exp_f32 v109, v109
  v_exp_f32 v110, v110
  v_cvt_pk_bf16_f32 v134, v108, v109
  v_exp_f32 v111, v111
  v_exp_f32 v112, v112
  v_cvt_pk_bf16_f32 v135, v110, v111
  v_mfma_f32_32x32x16_bf16 v[96:111], v[208:211], v[16:19], 0
  v_exp_f32 v113, v113
  v_exp_f32 v114, v114
  v_cvt_pk_bf16_f32 v136, v112, v113
  v_exp_f32 v115, v115
  v_mfma_f32_32x32x16_bf16 v[96:111], v[212:215], v[20:23], v[96:111]
  v_exp_f32 v116, v116
  v_cvt_pk_bf16_f32 v137, v114, v115
  v_exp_f32 v117, v117
  v_exp_f32 v118, v118
  v_cvt_pk_bf16_f32 v138, v116, v117
  v_exp_f32 v119, v119
  v_mfma_f32_32x32x16_bf16 v[64:79], v[200:203], v[128:131], 0
  s_xor_b32 s42, s70, 131072
  buffer_load_dwordx4 v[192:195], v8, s[24:27], s42 offen offset:0 sc1
  buffer_load_dwordx4 v[196:199], v8, s[24:27], s42 offen offset:1024 sc1
  buffer_store_dwordx4 v[36:39], v8, s[24:27], s59 offen sc1
  buffer_store_dwordx4 v[36:39], v8, s[24:27], s58 offen offset:0 sc1
  buffer_store_dwordx4 v[36:39], v8, s[24:27], s58 offen offset:1024 sc1
  v_exp_f32 v120, v120
  v_cvt_pk_bf16_f32 v139, v118, v119
  v_exp_f32 v121, v121
  v_exp_f32 v122, v122
  v_cvt_pk_bf16_f32 v140, v120, v121
  v_exp_f32 v123, v123
  v_mfma_f32_32x32x16_bf16 v[64:79], v[204:207], v[132:135], v[64:79]
  v_exp_f32 v124, v124
  v_cvt_pk_bf16_f32 v141, v122, v123
  v_exp_f32 v125, v125
  v_exp_f32 v126, v126
  v_cvt_pk_bf16_f32 v142, v124, v125
  v_exp_f32 v127, v127
  v_exp_f32 v96, v96
  v_cvt_pk_bf16_f32 v143, v126, v127
  v_mfma_f32_32x32x16_bf16 v[112:127], v[208:211], v[24:27], 0
  v_exp_f32 v97, v97
  v_exp_f32 v98, v98
  v_cvt_pk_bf16_f32 v128, v96, v97
  v_exp_f32 v99, v99
  v_mfma_f32_32x32x16_bf16 v[112:127], v[212:215], v[28:31], v[112:127]
  v_exp_f32 v100, v100
  v_cvt_pk_bf16_f32 v129, v98, v99
  v_exp_f32 v101, v101
  v_exp_f32 v102, v102
  v_cvt_pk_bf16_f32 v130, v100, v101
  v_exp_f32 v103, v103
  v_mfma_f32_32x32x16_bf16 v[80:95], v[200:203], v[136:139], 0
  s_xor_b32 s42, s71, 6144
  buffer_load_dwordx4 v[248:251], v5, s[24:27], s42 offen offset:0 sc1
  buffer_load_dwordx4 v[252:255], v5, s[24:27], s42 offen offset:1024 sc1
  s_add_u32 m0, s36, 106496
  s_mov_b32 s43, 0
  buffer_load_dwordx4 v4, s[20:23], s43 offen lds
  v_exp_f32 v104, v104
  v_cvt_pk_bf16_f32 v131, v102, v103
  v_exp_f32 v105, v105
  v_exp_f32 v106, v106
  v_cvt_pk_bf16_f32 v132, v104, v105
  v_exp_f32 v107, v107
  v_mfma_f32_32x32x16_bf16 v[80:95], v[204:207], v[140:143], v[80:95]
  v_exp_f32 v108, v108
  v_cvt_pk_bf16_f32 v133, v106, v107
  v_exp_f32 v109, v109
  v_exp_f32 v110, v110
  v_cvt_pk_bf16_f32 v134, v108, v109
  v_exp_f32 v111, v111
  v_exp_f32 v112, v112
  v_cvt_pk_bf16_f32 v135, v110, v111
  v_mfma_f32_32x32x16_bf16 v[96:111], v[224:227], v[16:19], 0
  v_exp_f32 v113, v113
  v_exp_f32 v114, v114
  v_cvt_pk_bf16_f32 v136, v112, v113
  v_exp_f32 v115, v115
  v_mfma_f32_32x32x16_bf16 v[96:111], v[228:231], v[20:23], v[96:111]
  v_exp_f32 v116, v116
  v_cvt_pk_bf16_f32 v137, v114, v115
  v_exp_f32 v117, v117
  v_exp_f32 v118, v118
  v_cvt_pk_bf16_f32 v138, v116, v117
  v_exp_f32 v119, v119
  v_mfma_f32_32x32x16_bf16 v[64:79], v[216:219], v[128:131], v[64:79]
  s_xor_b32 s42, s70, 163840
  buffer_load_dwordx4 v[208:211], v8, s[24:27], s42 offen offset:0 sc1
  buffer_load_dwordx4 v[212:215], v8, s[24:27], s42 offen offset:1024 sc1
  v_exp_f32 v120, v120
  v_cvt_pk_bf16_f32 v139, v118, v119
  v_exp_f32 v121, v121
  v_exp_f32 v122, v122
  v_cvt_pk_bf16_f32 v140, v120, v121
  v_exp_f32 v123, v123
  v_mfma_f32_32x32x16_bf16 v[64:79], v[220:223], v[132:135], v[64:79]
  v_exp_f32 v124, v124
  v_cvt_pk_bf16_f32 v141, v122, v123
  v_exp_f32 v125, v125
  v_exp_f32 v126, v126
  v_cvt_pk_bf16_f32 v142, v124, v125
  v_exp_f32 v127, v127
  v_exp_f32 v96, v96
  v_cvt_pk_bf16_f32 v143, v126, v127
  v_mfma_f32_32x32x16_bf16 v[112:127], v[224:227], v[24:27], 0
  v_exp_f32 v97, v97
  v_exp_f32 v98, v98
  v_cvt_pk_bf16_f32 v128, v96, v97
  v_exp_f32 v99, v99
  v_mfma_f32_32x32x16_bf16 v[112:127], v[228:231], v[28:31], v[112:127]
  v_exp_f32 v100, v100
  v_cvt_pk_bf16_f32 v129, v98, v99
  v_exp_f32 v101, v101
  v_exp_f32 v102, v102
  v_cvt_pk_bf16_f32 v130, v100, v101
  v_exp_f32 v103, v103
  v_mfma_f32_32x32x16_bf16 v[80:95], v[216:219], v[136:139], v[80:95]
  s_xor_b32 s42, s71, 8192
  buffer_load_dwordx4 v[200:203], v5, s[24:27], s42 offen offset:0 sc1
  buffer_load_dwordx4 v[204:207], v5, s[24:27], s42 offen offset:1024 sc1
  s_add_u32 m0, s36, 114688
  s_mov_b32 s43, 57344
  buffer_load_dwordx4 v4, s[20:23], s43 offen lds
  v_exp_f32 v104, v104
  v_cvt_pk_bf16_f32 v131, v102, v103
  v_exp_f32 v105, v105
  v_exp_f32 v106, v106
  v_cvt_pk_bf16_f32 v132, v104, v105
  v_exp_f32 v107, v107
  v_mfma_f32_32x32x16_bf16 v[80:95], v[220:223], v[140:143], v[80:95]
  v_exp_f32 v108, v108
  v_cvt_pk_bf16_f32 v133, v106, v107
  v_exp_f32 v109, v109
  v_exp_f32 v110, v110
  v_cvt_pk_bf16_f32 v134, v108, v109
  v_exp_f32 v111, v111
  v_exp_f32 v112, v112
  v_cvt_pk_bf16_f32 v135, v110, v111
  v_mfma_f32_32x32x16_bf16 v[96:111], v[240:243], v[16:19], 0
  v_exp_f32 v113, v113
  v_exp_f32 v114, v114
  v_cvt_pk_bf16_f32 v136, v112, v113
  v_exp_f32 v115, v115
  v_mfma_f32_32x32x16_bf16 v[96:111], v[244:247], v[20:23], v[96:111]
  v_exp_f32 v116, v116
  v_cvt_pk_bf16_f32 v137, v114, v115
  v_exp_f32 v117, v117
  v_exp_f32 v118, v118
  v_cvt_pk_bf16_f32 v138, v116, v117
  v_exp_f32 v119, v119
  s_waitcnt vmcnt(13)
  v_mfma_f32_32x32x16_bf16 v[64:79], v[232:235], v[128:131], v[64:79]
  s_xor_b32 s42, s70, 196608
  buffer_load_dwordx4 v[224:227], v8, s[24:27], s42 offen offset:0 sc1
  buffer_load_dwordx4 v[228:231], v8, s[24:27], s42 offen offset:1024 sc1
  v_exp_f32 v120, v120
  v_cvt_pk_bf16_f32 v139, v118, v119
  v_exp_f32 v121, v121
  v_exp_f32 v122, v122
  v_cvt_pk_bf16_f32 v140, v120, v121
  v_exp_f32 v123, v123
  v_mfma_f32_32x32x16_bf16 v[64:79], v[236:239], v[132:135], v[64:79]
  v_exp_f32 v124, v124
  v_cvt_pk_bf16_f32 v141, v122, v123
  v_exp_f32 v125, v125
  v_exp_f32 v126, v126
  v_cvt_pk_bf16_f32 v142, v124, v125
  v_exp_f32 v127, v127
  v_exp_f32 v96, v96
  v_cvt_pk_bf16_f32 v143, v126, v127
  v_mfma_f32_32x32x16_bf16 v[112:127], v[240:243], v[24:27], 0
  v_exp_f32 v97, v97
  v_exp_f32 v98, v98
  v_cvt_pk_bf16_f32 v128, v96, v97
  v_exp_f32 v99, v99
  v_mfma_f32_32x32x16_bf16 v[112:127], v[244:247], v[28:31], v[112:127]
  v_exp_f32 v100, v100
  v_cvt_pk_bf16_f32 v129, v98, v99
  v_exp_f32 v101, v101
  v_exp_f32 v102, v102
  v_cvt_pk_bf16_f32 v130, v100, v101
  v_exp_f32 v103, v103
  v_mfma_f32_32x32x16_bf16 v[80:95], v[232:235], v[136:139], v[80:95]
  s_xor_b32 s42, s71, 10240
  buffer_load_dwordx4 v[216:219], v5, s[24:27], s42 offen offset:0 sc1
  buffer_load_dwordx4 v[220:223], v5, s[24:27], s42 offen offset:1024 sc1
  s_add_u32 m0, s36, 122880
  s_mov_b32 s43, 114688
  buffer_load_dwordx4 v4, s[20:23], s43 offen lds
  s_lshl_b32 s34, s56, 4
  s_add_u32 s34, s34, s55
  s_lshl_b32 s34, s34, 3
  s_add_u32 s34, s34, s31
  s_lshl_b32 s34, s34, 3
  s_add_u32 s34, s34, 17858560
  s_waitcnt vmcnt(13)
  v_mov_b32 v14, s50
  v_mov_b32 v15, s51
  s_mov_b64 exec, 1
  buffer_store_dwordx2 v[14:15], v9, s[24:27], s34 offen sc0 sc1
  s_mov_b64 exec, -1
  v_exp_f32 v104, v104
  v_cvt_pk_bf16_f32 v131, v102, v103
  v_exp_f32 v105, v105
  v_exp_f32 v106, v106
  v_cvt_pk_bf16_f32 v132, v104, v105
  v_exp_f32 v107, v107
  v_mfma_f32_32x32x16_bf16 v[80:95], v[236:239], v[140:143], v[80:95]
  v_exp_f32 v108, v108
  v_cvt_pk_bf16_f32 v133, v106, v107
  v_exp_f32 v109, v109
  v_exp_f32 v110, v110
  v_cvt_pk_bf16_f32 v134, v108, v109
  v_exp_f32 v111, v111
  v_exp_f32 v112, v112
  v_cvt_pk_bf16_f32 v135, v110, v111
  v_mfma_f32_32x32x16_bf16 v[96:111], v[192:195], v[16:19], 0
  v_exp_f32 v113, v113
  v_exp_f32 v114, v114
  v_cvt_pk_bf16_f32 v136, v112, v113
  v_exp_f32 v115, v115
  v_mfma_f32_32x32x16_bf16 v[96:111], v[196:199], v[20:23], v[96:111]
  v_exp_f32 v116, v116
  v_cvt_pk_bf16_f32 v137, v114, v115
  v_exp_f32 v117, v117
  v_exp_f32 v118, v118
  v_cvt_pk_bf16_f32 v138, v116, v117
  v_exp_f32 v119, v119
  s_waitcnt vmcnt(12)
  v_mfma_f32_32x32x16_bf16 v[64:79], v[248:251], v[128:131], v[64:79]
  s_xor_b32 s42, s70, 229376
  buffer_load_dwordx4 v[240:243], v8, s[24:27], s42 offen offset:0 sc1
  buffer_load_dwordx4 v[244:247], v8, s[24:27], s42 offen offset:1024 sc1
  v_exp_f32 v120, v120
  v_cvt_pk_bf16_f32 v139, v118, v119
  v_exp_f32 v121, v121
  v_exp_f32 v122, v122
  v_cvt_pk_bf16_f32 v140, v120, v121
  v_exp_f32 v123, v123
  v_mfma_f32_32x32x16_bf16 v[64:79], v[252:255], v[132:135], v[64:79]
  v_exp_f32 v124, v124
  v_cvt_pk_bf16_f32 v141, v122, v123
  v_exp_f32 v125, v125
  v_exp_f32 v126, v126
  v_cvt_pk_bf16_f32 v142, v124, v125
  v_exp_f32 v127, v127
  v_exp_f32 v96, v96
  v_cvt_pk_bf16_f32 v143, v126, v127
  v_mfma_f32_32x32x16_bf16 v[112:127], v[192:195], v[24:27], 0
  v_exp_f32 v97, v97
  v_exp_f32 v98, v98
  v_cvt_pk_bf16_f32 v128, v96, v97
  v_exp_f32 v99, v99
  v_mfma_f32_32x32x16_bf16 v[112:127], v[196:199], v[28:31], v[112:127]
  v_exp_f32 v100, v100
  v_cvt_pk_bf16_f32 v129, v98, v99
  v_exp_f32 v101, v101
  v_exp_f32 v102, v102
  v_cvt_pk_bf16_f32 v130, v100, v101
  v_exp_f32 v103, v103
  v_mfma_f32_32x32x16_bf16 v[80:95], v[248:251], v[136:139], v[80:95]
  s_xor_b32 s42, s71, 12288
  buffer_load_dwordx4 v[232:235], v5, s[24:27], s42 offen offset:0 sc1
  buffer_load_dwordx4 v[236:239], v5, s[24:27], s42 offen offset:1024 sc1
  s_add_u32 m0, s36, 131072
  s_mov_b32 s43, 172032
  buffer_load_dwordx4 v4, s[20:23], s43 offen lds
  v_exp_f32 v104, v104
  v_cvt_pk_bf16_f32 v131, v102, v103
  v_exp_f32 v105, v105
  v_exp_f32 v106, v106
  v_cvt_pk_bf16_f32 v132, v104, v105
  v_exp_f32 v107, v107
  v_mfma_f32_32x32x16_bf16 v[80:95], v[252:255], v[140:143], v[80:95]
  v_exp_f32 v108, v108
  v_cvt_pk_bf16_f32 v133, v106, v107
  v_exp_f32 v109, v109
  v_exp_f32 v110, v110
  v_cvt_pk_bf16_f32 v134, v108, v109
  v_exp_f32 v111, v111
  v_exp_f32 v112, v112
  v_cvt_pk_bf16_f32 v135, v110, v111
  s_waitcnt vmcnt(14)
  v_mfma_f32_32x32x16_bf16 v[96:111], v[208:211], v[16:19], 0
  v_exp_f32 v113, v113
  v_exp_f32 v114, v114
  v_cvt_pk_bf16_f32 v136, v112, v113
  v_exp_f32 v115, v115
  v_mfma_f32_32x32x16_bf16 v[96:111], v[212:215], v[20:23], v[96:111]
  v_exp_f32 v116, v116
  v_cvt_pk_bf16_f32 v137, v114, v115
  v_exp_f32 v117, v117
  v_exp_f32 v118, v118
  v_cvt_pk_bf16_f32 v138, v116, v117
  v_exp_f32 v119, v119
  s_waitcnt vmcnt(12)
  v_mfma_f32_32x32x16_bf16 v[64:79], v[200:203], v[128:131], v[64:79]
  s_xor_b32 s42, s70, 262144
  buffer_load_dwordx4 v[192:195], v8, s[24:27], s42 offen offset:0 sc1
  buffer_load_dwordx4 v[196:199], v8, s[24:27], s42 offen offset:1024 sc1
  v_exp_f32 v120, v120
  v_cvt_pk_bf16_f32 v139, v118, v119
  v_exp_f32 v121, v121
  v_exp_f32 v122, v122
  v_cvt_pk_bf16_f32 v140, v120, v121
  v_exp_f32 v123, v123
  v_mfma_f32_32x32x16_bf16 v[64:79], v[204:207], v[132:135], v[64:79]
  v_exp_f32 v124, v124
  v_cvt_pk_bf16_f32 v141, v122, v123
  v_exp_f32 v125, v125
  v_exp_f32 v126, v126
  v_cvt_pk_bf16_f32 v142, v124, v125
  v_exp_f32 v127, v127
  v_exp_f32 v96, v96
  v_cvt_pk_bf16_f32 v143, v126, v127
  v_mfma_f32_32x32x16_bf16 v[112:127], v[208:211], v[24:27], 0
  v_exp_f32 v97, v97
  v_exp_f32 v98, v98
  v_cvt_pk_bf16_f32 v128, v96, v97
  v_exp_f32 v99, v99
  v_mfma_f32_32x32x16_bf16 v[112:127], v[212:215], v[28:31], v[112:127]
  v_exp_f32 v100, v100
  v_cvt_pk_bf16_f32 v129, v98, v99
  v_exp_f32 v101, v101
  v_exp_f32 v102, v102
  v_cvt_pk_bf16_f32 v130, v100, v101
  v_exp_f32 v103, v103
  v_mfma_f32_32x32x16_bf16 v[80:95], v[200:203], v[136:139], v[80:95]
  s_cmp_lt_u32 s31, 4
  s_cselect_b64 vcc, -1, 0
  s_cbranch_vccz LS18
  s_mul_i32 s33, s55, 7
  s_lshr_b32 s34, s33, 4
  s_add_u32 s35, s33, 6
  s_lshr_b32 s35, s35, 4
  s_sub_u32 s35, s35, s34
  s_lshl_b32 s35, s35, 11
  s_lshl_b32 s34, s34, 11
  s_lshl_b32 s33, s56, 7
  s_add_u32 s34, s34, s33
  s_add_u32 s34, s34, 17842176
  v_and_b32 v10, 1, v1
  v_mul_u32_u24 v10, s35, v10
  v_add_u32 v10, s34, v10
  s_lshl_b32 s33, s55, 7
  s_add_u32 s33, s33, 16842752
  buffer_load_dword v14, v9, s[24:27], s33 offen sc1
  buffer_load_dwordx2 v[6:7], v10, s[24:27], 0 offen sc1
LS18:
  s_xor_b32 s42, s71, 14336
  buffer_load_dwordx4 v[248:251], v5, s[24:27], s42 offen offset:0 sc1
  buffer_load_dwordx4 v[252:255], v5, s[24:27], s42 offen offset:1024 sc1
  s_add_u32 m0, s36, 139264
  s_mov_b32 s43, 229376
  buffer_load_dwordx4 v4, s[20:23], s43 offen lds
  v_exp_f32 v104, v104
  v_cvt_pk_bf16_f32 v131, v102, v103
  v_exp_f32 v105, v105
  v_exp_f32 v106, v106
  v_cvt_pk_bf16_f32 v132, v104, v105
  v_exp_f32 v107, v107
  v_mfma_f32_32x32x16_bf16 v[80:95], v[204:207], v[140:143], v[80:95]
  v_exp_f32 v108, v108
  v_cvt_pk_bf16_f32 v133, v106, v107
  v_exp_f32 v109, v109
  v_exp_f32 v110, v110
  v_cvt_pk_bf16_f32 v134, v108, v109
  v_exp_f32 v111, v111
  v_exp_f32 v112, v112
  v_cvt_pk_bf16_f32 v135, v110, v111
  s_waitcnt vmcnt(16)
  s_cbranch_vccnz LW19
  s_waitcnt vmcnt(14)
LW19:
  v_mfma_f32_32x32x16_bf16 v[96:111], v[224:227], v[16:19], 0
  v_exp_f32 v113, v113
  v_exp_f32 v114, v114
  v_cvt_pk_bf16_f32 v136, v112, v113
  v_exp_f32 v115, v115
  v_mfma_f32_32x32x16_bf16 v[96:111], v[228:231], v[20:23], v[96:111]
  v_exp_f32 v116, v116
  v_cvt_pk_bf16_f32 v137, v114, v115
  v_exp_f32 v117, v117
  v_exp_f32 v118, v118
  v_cvt_pk_bf16_f32 v138, v116, v117
  v_exp_f32 v119, v119
  s_waitcnt vmcnt(14)
  s_cbranch_vccnz LW20
  s_waitcnt vmcnt(12)
LW20:
  v_mfma_f32_32x32x16_bf16 v[64:79], v[216:219], v[128:131], v[64:79]
  s_xor_b32 s42, s70, 294912
  buffer_load_dwordx4 v[208:211], v8, s[24:27], s42 offen offset:0 sc1
  buffer_load_dwordx4 v[212:215], v8, s[24:27], s42 offen offset:1024 sc1
  v_exp_f32 v120, v120
  v_cvt_pk_bf16_f32 v139, v118, v119
  v_exp_f32 v121, v121
  v_exp_f32 v122, v122
  v_cvt_pk_bf16_f32 v140, v120, v121
  v_exp_f32 v123, v123
  v_mfma_f32_32x32x16_bf16 v[64:79], v[220:223], v[132:135], v[64:79]
  v_exp_f32 v124, v124
  v_cvt_pk_bf16_f32 v141, v122, v123
  v_exp_f32 v125, v125
  v_exp_f32 v126, v126
  v_cvt_pk_bf16_f32 v142, v124, v125
  v_exp_f32 v127, v127
  v_exp_f32 v96, v96
  v_cvt_pk_bf16_f32 v143, v126, v127
  v_mfma_f32_32x32x16_bf16 v[112:127], v[224:227], v[24:27], 0
  v_exp_f32 v97, v97
  v_exp_f32 v98, v98
  v_cvt_pk_bf16_f32 v128, v96, v97
  v_exp_f32 v99, v99
  v_mfma_f32_32x32x16_bf16 v[112:127], v[228:231], v[28:31], v[112:127]
  v_exp_f32 v100, v100
  v_cvt_pk_bf16_f32 v129, v98, v99
  v_exp_f32 v101, v101
  v_exp_f32 v102, v102
  v_cvt_pk_bf16_f32 v130, v100, v101
  v_exp_f32 v103, v103
  v_mfma_f32_32x32x16_bf16 v[80:95], v[216:219], v[136:139], v[80:95]
  s_xor_b32 s42, s71, 16384
  buffer_load_dwordx4 v[200:203], v5, s[24:27], s42 offen offset:0 sc1
  buffer_load_dwordx4 v[204:207], v5, s[24:27], s42 offen offset:1024 sc1
  s_add_u32 m0, s36, 147456
  s_mov_b32 s43, 286720
  buffer_load_dwordx4 v4, s[20:23], s43 offen lds
  v_exp_f32 v104, v104
  v_cvt_pk_bf16_f32 v131, v102, v103
  v_exp_f32 v105, v105
  v_exp_f32 v106, v106
  v_cvt_pk_bf16_f32 v132, v104, v105
  v_exp_f32 v107, v107
  v_mfma_f32_32x32x16_bf16 v[80:95], v[220:223], v[140:143], v[80:95]
  v_exp_f32 v108, v108
  v_cvt_pk_bf16_f32 v133, v106, v107
  v_exp_f32 v109, v109
  v_exp_f32 v110, v110
  v_cvt_pk_bf16_f32 v134, v108, v109
  v_exp_f32 v111, v111
  v_exp_f32 v112, v112
  v_cvt_pk_bf16_f32 v135, v110, v111
  s_waitcnt vmcnt(15)
  s_cbranch_vccnz LW21
  s_waitcnt vmcnt(13)
LW21:
  v_mfma_f32_32x32x16_bf16 v[96:111], v[240:243], v[16:19], 0
  v_exp_f32 v113, v113
  v_exp_f32 v114, v114
  v_cvt_pk_bf16_f32 v136, v112, v113
  v_exp_f32 v115, v115
  v_mfma_f32_32x32x16_bf16 v[96:111], v[244:247], v[20:23], v[96:111]
  v_exp_f32 v116, v116
  v_cvt_pk_bf16_f32 v137, v114, v115
  v_exp_f32 v117, v117
  v_exp_f32 v118, v118
  v_cvt_pk_bf16_f32 v138, v116, v117
  v_exp_f32 v119, v119
  s_waitcnt vmcnt(13)
  s_cbranch_vccnz LW22
  s_waitcnt vmcnt(11)
LW22:
  v_mfma_f32_32x32x16_bf16 v[64:79], v[232:235], v[128:131], v[64:79]
  s_xor_b32 s42, s70, 327680
  buffer_load_dwordx4 v[224:227], v8, s[24:27], s42 offen offset:0 sc1
  buffer_load_dwordx4 v[228:231], v8, s[24:27], s42 offen offset:1024 sc1
  v_exp_f32 v120, v120
  v_cvt_pk_bf16_f32 v139, v118, v119
  v_exp_f32 v121, v121
  v_exp_f32 v122, v122
  v_cvt_pk_bf16_f32 v140, v120, v121
  v_exp_f32 v123, v123
  v_mfma_f32_32x32x16_bf16 v[64:79], v[236:239], v[132:135], v[64:79]
  v_exp_f32 v124, v124
  v_cvt_pk_bf16_f32 v141, v122, v123
  v_exp_f32 v125, v125
  v_exp_f32 v126, v126
  v_cvt_pk_bf16_f32 v142, v124, v125
  v_exp_f32 v127, v127
  v_exp_f32 v96, v96
  v_cvt_pk_bf16_f32 v143, v126, v127
  v_mfma_f32_32x32x16_bf16 v[112:127], v[240:243], v[24:27], 0
  v_exp_f32 v97, v97
  v_exp_f32 v98, v98
  v_cvt_pk_bf16_f32 v128, v96, v97
  v_exp_f32 v99, v99
  v_mfma_f32_32x32x16_bf16 v[112:127], v[244:247], v[28:31], v[112:127]
  v_exp_f32 v100, v100
  v_cvt_pk_bf16_f32 v129, v98, v99
  v_exp_f32 v101, v101
  v_exp_f32 v102, v102
  v_cvt_pk_bf16_f32 v130, v100, v101
  v_exp_f32 v103, v103
  v_mfma_f32_32x32x16_bf16 v[80:95], v[232:235], v[136:139], v[80:95]
  s_xor_b32 s42, s71, 18432
  buffer_load_dwordx4 v[216:219], v5, s[24:27], s42 offen offset:0 sc1
  buffer_load_dwordx4 v[220:223], v5, s[24:27], s42 offen offset:1024 sc1
  s_add_u32 m0, s36, 155648
  s_mov_b32 s43, 344064
  buffer_load_dwordx4 v4, s[20:23], s43 offen lds
  v_exp_f32 v104, v104
  v_cvt_pk_bf16_f32 v131, v102, v103
  v_exp_f32 v105, v105
  v_exp_f32 v106, v106
  v_cvt_pk_bf16_f32 v132, v104, v105
  v_exp_f32 v107, v107
  v_mfma_f32_32x32x16_bf16 v[80:95], v[236:239], v[140:143], v[80:95]
  v_exp_f32 v108, v108
  v_cvt_pk_bf16_f32 v133, v106, v107
  v_exp_f32 v109, v109
  v_exp_f32 v110, v110
  v_cvt_pk_bf16_f32 v134, v108, v109
  v_exp_f32 v111, v111
  v_exp_f32 v112, v112
  v_cvt_pk_bf16_f32 v135, v110, v111
  s_waitcnt vmcnt(15)
  s_cbranch_vccnz LW23
  s_waitcnt vmcnt(13)
LW23:
  v_mfma_f32_32x32x16_bf16 v[96:111], v[192:195], v[16:19], 0
  v_exp_f32 v113, v113
  v_exp_f32 v114, v114
  v_cvt_pk_bf16_f32 v136, v112, v113
  v_exp_f32 v115, v115
  v_mfma_f32_32x32x16_bf16 v[96:111], v[196:199], v[20:23], v[96:111]
  v_exp_f32 v116, v116
  v_cvt_pk_bf16_f32 v137, v114, v115
  v_exp_f32 v117, v117
  v_exp_f32 v118, v118
  v_cvt_pk_bf16_f32 v138, v116, v117
  v_exp_f32 v119, v119
  s_waitcnt vmcnt(11)
  v_mfma_f32_32x32x16_bf16 v[64:79], v[248:251], v[128:131], v[64:79]
  s_cbranch_vccz LS24
  s_waitcnt vmcnt(13)
  s_mov_b32 s52, 20000
LP25:
  v_cmp_gt_u32 s[48:49], 16, v14
  v_cmp_ne_u64 s[34:35], s[50:51], v[6:7]
  s_nop 0
  s_or_b64 s[48:49], s[48:49], s[34:35]
  s_cmp_eq_u64 s[48:49], 0
  s_cbranch_scc1 LD26
  s_sub_u32 s52, s52, 1
  s_cbranch_scc1 LD26
  s_sleep 4
  buffer_load_dword v14, v9, s[24:27], s33 offen sc1
  buffer_load_dwordx2 v[6:7], v10, s[24:27], 0 offen sc1
  s_waitcnt vmcnt(0)
  s_branch LP25
LD26:
  s_lshl_b32 s34, s55, 12
  s_add_u32 s34, s34, 16777216
  s_lshl_b32 s35, s56, 2
  s_add_u32 s35, s35, s60
  s_mul_i32 s35, s35, 28672
  s_add_u32 s35, s35, s29
  s_add_u32 s35, s35, 6291456
  buffer_load_dword v144, v13, s[24:27], s34 offen offset:0 sc1
  buffer_load_dword v145, v13, s[24:27], s34 offen offset:256 sc1
  buffer_load_dword v146, v13, s[24:27], s34 offen offset:512 sc1
  buffer_load_dword v147, v13, s[24:27], s34 offen offset:768 sc1
  buffer_load_dword v148, v13, s[24:27], s34 offen offset:1024 sc1
  buffer_load_dword v149, v13, s[24:27], s34 offen offset:1280 sc1
  buffer_load_dword v150, v13, s[24:27], s34 offen offset:1536 sc1
  buffer_load_dword v151, v13, s[24:27], s34 offen offset:1792 sc1
  buffer_load_dword v152, v13, s[24:27], s34 offen offset:2048 sc1
  buffer_load_dword v153, v13, s[24:27], s34 offen offset:2304 sc1
  buffer_load_dword v154, v13, s[24:27], s34 offen offset:2560 sc1
  buffer_load_dword v155, v13, s[24:27], s34 offen offset:2816 sc1
  buffer_load_dword v156, v13, s[24:27], s34 offen offset:3072 sc1
  buffer_load_dword v157, v13, s[24:27], s34 offen offset:3328 sc1
  buffer_load_dword v158, v13, s[24:27], s34 offen offset:3584 sc1
  buffer_load_dword v159, v13, s[24:27], s34 offen offset:3840 sc1
  buffer_load_dwordx4 v[168:171], v8, s[24:27], s35 offen offset:0 sc1
  buffer_load_dwordx4 v[172:175], v8, s[24:27], s35 offen offset:1024 sc1
LS24:
  s_xor_b32 s42, s70, 360448
  buffer_load_dwordx4 v[240:243], v8, s[24:27], s42 offen offset:0 sc1
  buffer_load_dwordx4 v[244:247], v8, s[24:27], s42 offen offset:1024 sc1
  v_exp_f32 v120, v120
  v_cvt_pk_bf16_f32 v139, v118, v119
  v_exp_f32 v121, v121
  v_exp_f32 v122, v122
  v_cvt_pk_bf16_f32 v140, v120, v121
  v_exp_f32 v123, v123
  v_mfma_f32_32x32x16_bf16 v[64:79], v[252:255], v[132:135], v[64:79]
  v_exp_f32 v124, v124
  v_cvt_pk_bf16_f32 v141, v122, v123
  v_exp_f32 v125, v125
  v_exp_f32 v126, v126
  v_cvt_pk_bf16_f32 v142, v124, v125
  v_exp_f32 v127, v127
  s_setprio 2
  v_exp_f32 v96, v96
  v_cvt_pk_bf16_f32 v143, v126, v127
  v_mfma_f32_32x32x16_bf16 v[112:127], v[192:195], v[24:27], 0
  v_exp_f32 v97, v97
  v_exp_f32 v98, v98
  v_cvt_pk_bf16_f32 v128, v96, v97
  v_exp_f32 v99, v99
  v_mfma_f32_32x32x16_bf16 v[112:127], v[196:199], v[28:31], v[112:127]
  v_exp_f32 v100, v100
  v_cvt_pk_bf16_f32 v129, v98, v99
  v_exp_f32 v101, v101
  v_exp_f32 v102, v102
  v_cvt_pk_bf16_f32 v130, v100, v101
  v_exp_f32 v103, v103
  v_mfma_f32_32x32x16_bf16 v[80:95], v[248:251], v[136:139], v[80:95]
  s_xor_b32 s42, s71, 20480
  buffer_load_dwordx4 v[232:235], v5, s[24:27], s42 offen offset:0 sc1
  buffer_load_dwordx4 v[236:239], v5, s[24:27], s42 offen offset:1024 sc1
  s_add_u32 m0, s36, 49152
  s_mov_b32 s43, 0
  buffer_load_dwordx4 v4, s[16:19], s43 offen lds
  v_exp_f32 v104, v104
  v_cvt_pk_bf16_f32 v131, v102, v103
  v_exp_f32 v105, v105
  v_exp_f32 v106, v106
  v_cvt_pk_bf16_f32 v132, v104, v105
  v_exp_f32 v107, v107
  v_mfma_f32_32x32x16_bf16 v[80:95], v[252:255], v[140:143], v[80:95]
  v_exp_f32 v108, v108
  v_cvt_pk_bf16_f32 v133, v106, v107
  v_exp_f32 v109, v109
  v_exp_f32 v110, v110
  v_cvt_pk_bf16_f32 v134, v108, v109
  v_exp_f32 v111, v111
  v_exp_f32 v112, v112
  v_cvt_pk_bf16_f32 v135, v110, v111
  s_waitcnt vmcnt(31)
  s_cbranch_vccnz LW27
  s_waitcnt vmcnt(13)
LW27:
  v_mfma_f32_32x32x16_bf16 v[96:111], v[208:211], v[16:19], 0
  v_exp_f32 v113, v113
  v_exp_f32 v114, v114
  v_cvt_pk_bf16_f32 v136, v112, v113
  v_exp_f32 v115, v115
  v_mfma_f32_32x32x16_bf16 v[96:111], v[212:215], v[20:23], v[96:111]
  v_exp_f32 v116, v116
  v_cvt_pk_bf16_f32 v137, v114, v115
  v_exp_f32 v117, v117
  v_exp_f32 v118, v118
  v_cvt_pk_bf16_f32 v138, v116, v117
  v_exp_f32 v119, v119
  s_waitcnt vmcnt(29)
  s_cbranch_vccnz LW28
  s_waitcnt vmcnt(11)
LW28:
  v_mfma_f32_32x32x16_bf16 v[64:79], v[200:203], v[128:131], v[64:79]
  s_xor_b32 s42, s70, 393216
  buffer_load_dwordx4 v[192:195], v8, s[24:27], s42 offen offset:0 sc1
  buffer_load_dwordx4 v[196:199], v8, s[24:27], s42 offen offset:1024 sc1
  v_exp_f32 v120, v120
  v_cvt_pk_bf16_f32 v139, v118, v119
  v_exp_f32 v121, v121
  v_exp_f32 v122, v122
  v_cvt_pk_bf16_f32 v140, v120, v121
  v_exp_f32 v123, v123
  v_mfma_f32_32x32x16_bf16 v[64:79], v[204:207], v[132:135], v[64:79]
  v_exp_f32 v124, v124
  v_cvt_pk_bf16_f32 v141, v122, v123
  v_exp_f32 v125, v125
  v_exp_f32 v126, v126
  v_cvt_pk_bf16_f32 v142, v124, v125
  v_exp_f32 v127, v127
  v_exp_f32 v96, v96
  v_cvt_pk_bf16_f32 v143, v126, v127
  v_mfma_f32_32x32x16_bf16 v[112:127], v[208:211], v[24:27], 0
  v_exp_f32 v97, v97
  v_exp_f32 v98, v98
  v_cvt_pk_bf16_f32 v128, v96, v97
  v_exp_f32 v99, v99
  v_mfma_f32_32x32x16_bf16 v[112:127], v[212:215], v[28:31], v[112:127]
  v_exp_f32 v100, v100
  v_cvt_pk_bf16_f32 v129, v98, v99
  v_exp_f32 v101, v101
  v_exp_f32 v102, v102
  v_cvt_pk_bf16_f32 v130, v100, v101
  v_exp_f32 v103, v103
  v_mfma_f32_32x32x16_bf16 v[80:95], v[200:203], v[136:139], v[80:95]
  s_xor_b32 s42, s71, 22528
  buffer_load_dwordx4 v[248:251], v5, s[24:27], s42 offen offset:0 sc1
  buffer_load_dwordx4 v[252:255], v5, s[24:27], s42 offen offset:1024 sc1
  s_add_u32 m0, s36, 57344
  s_mov_b32 s43, 57344
  buffer_load_dwordx4 v4, s[16:19], s43 offen lds
  v_exp_f32 v104, v104
  v_cvt_pk_bf16_f32 v131, v102, v103
  v_exp_f32 v105, v105
  v_exp_f32 v106, v106
  v_cvt_pk_bf16_f32 v132, v104, v105
  v_exp_f32 v107, v107
  v_mfma_f32_32x32x16_bf16 v[80:95], v[204:207], v[140:143], v[80:95]
  v_exp_f32 v108, v108
  v_cvt_pk_bf16_f32 v133, v106, v107
  v_exp_f32 v109, v109
  v_exp_f32 v110, v110
  v_cvt_pk_bf16_f32 v134, v108, v109
  v_exp_f32 v111, v111
  v_exp_f32 v112, v112
  v_cvt_pk_bf16_f32 v135, v110, v111
  s_waitcnt vmcnt(31)
  s_cbranch_vccnz LW29
  s_waitcnt vmcnt(13)
LW29:
  v_mfma_f32_32x32x16_bf16 v[96:111], v[224:227], v[16:19], 0
  v_exp_f32 v113, v113
  v_exp_f32 v114, v114
  v_cvt_pk_bf16_f32 v136, v112, v113
  v_exp_f32 v115, v115
  v_mfma_f32_32x32x16_bf16 v[96:111], v[228:231], v[20:23], v[96:111]
  v_exp_f32 v116, v116
  v_cvt_pk_bf16_f32 v137, v114, v115
  v_exp_f32 v117, v117
  v_exp_f32 v118, v118
  v_cvt_pk_bf16_f32 v138, v116, v117
  v_exp_f32 v119, v119
  s_waitcnt vmcnt(29)
  s_cbranch_vccnz LW30
  s_waitcnt vmcnt(11)
LW30:
  v_mfma_f32_32x32x16_bf16 v[64:79], v[216:219], v[128:131], v[64:79]
  s_xor_b32 s42, s70, 425984
  buffer_load_dwordx4 v[208:211], v8, s[24:27], s42 offen offset:0 sc1
  buffer_load_dwordx4 v[212:215], v8, s[24:27], s42 offen offset:1024 sc1
  v_exp_f32 v120, v120
  v_cvt_pk_bf16_f32 v139, v118, v119
  v_exp_f32 v121, v121
  v_exp_f32 v122, v122
  v_cvt_pk_bf16_f32 v140, v120, v121
  v_exp_f32 v123, v123
  v_mfma_f32_32x32x16_bf16 v[64:79], v[220:223], v[132:135], v[64:79]
  v_exp_f32 v124, v124
  v_cvt_pk_bf16_f32 v141, v122, v123
  v_exp_f32 v125, v125
  v_exp_f32 v126, v126
  v_cvt_pk_bf16_f32 v142, v124, v125
  v_exp_f32 v127, v127
  v_exp_f32 v96, v96
  v_cvt_pk_bf16_f32 v143, v126, v127
  v_mfma_f32_32x32x16_bf16 v[112:127], v[224:227], v[24:27], 0
  v_exp_f32 v97, v97
  v_exp_f32 v98, v98
  v_cvt_pk_bf16_f32 v128, v96, v97
  v_exp_f32 v99, v99
  v_mfma_f32_32x32x16_bf16 v[112:127], v[228:231], v[28:31], v[112:127]
  v_exp_f32 v100, v100
  v_cvt_pk_bf16_f32 v129, v98, v99
  v_exp_f32 v101, v101
  v_exp_f32 v102, v102
  v_cvt_pk_bf16_f32 v130, v100, v101
  v_exp_f32 v103, v103
  v_mfma_f32_32x32x16_bf16 v[80:95], v[216:219], v[136:139], v[80:95]
  s_xor_b32 s42, s71, 24576
  buffer_load_dwordx4 v[200:203], v5, s[24:27], s42 offen offset:0 sc1
  buffer_load_dwordx4 v[204:207], v5, s[24:27], s42 offen offset:1024 sc1
  s_add_u32 m0, s36, 65536
  s_mov_b32 s43, 114688
  buffer_load_dwordx4 v4, s[16:19], s43 offen lds
  v_exp_f32 v104, v104
  v_cvt_pk_bf16_f32 v131, v102, v103
  v_exp_f32 v105, v105
  v_exp_f32 v106, v106
  v_cvt_pk_bf16_f32 v132, v104, v105
  v_exp_f32 v107, v107
  v_mfma_f32_32x32x16_bf16 v[80:95], v[220:223], v[140:143], v[80:95]
  v_exp_f32 v108, v108
  v_cvt_pk_bf16_f32 v133, v106, v107
  v_exp_f32 v109, v109
  v_exp_f32 v110, v110
  v_cvt_pk_bf16_f32 v134, v108, v109
  v_exp_f32 v111, v111
  v_exp_f32 v112, v112
  v_cvt_pk_bf16_f32 v135, v110, v111
  s_waitcnt vmcnt(13)
  v_mfma_f32_32x32x16_bf16 v[96:111], v[240:243], v[16:19], 0
  v_exp_f32 v113, v113
  v_exp_f32 v114, v114
  v_cvt_pk_bf16_f32 v136, v112, v113
  v_exp_f32 v115, v115
  v_mfma_f32_32x32x16_bf16 v[96:111], v[244:247], v[20:23], v[96:111]
  v_exp_f32 v116, v116
  v_cvt_pk_bf16_f32 v137, v114, v115
  v_exp_f32 v117, v117
  v_exp_f32 v118, v118
  v_cvt_pk_bf16_f32 v138, v116, v117
  v_exp_f32 v119, v119
  s_waitcnt vmcnt(11)
  v_mfma_f32_32x32x16_bf16 v[64:79], v[232:235], v[128:131], v[64:79]
  s_cbranch_vccz LS31
  s_waitcnt vmcnt(15)
  v_cvt_pk_bf16_f32 v160, v144, v145
  v_cvt_pk_bf16_f32 v161, v146, v147
  v_cvt_pk_bf16_f32 v162, v148, v149
  v_cvt_pk_bf16_f32 v163, v150, v151
  v_cvt_pk_bf16_f32 v164, v152, v153
  v_cvt_pk_bf16_f32 v165, v154, v155
  v_cvt_pk_bf16_f32 v166, v156, v157
  v_cvt_pk_bf16_f32 v167, v158, v159
  v_cndmask_b32 v168, v168, 0, s[38:39]
  v_cndmask_b32 v169, v169, 0, s[38:39]
  v_cndmask_b32 v174, v174, 0, s[40:41]
  v_cndmask_b32 v175, v175, 0, s[40:41]
  s_nop 1
  v_mfma_f32_32x32x16_bf16 v[176:191], v[160:163], v[168:171], 0
  v_mfma_f32_32x32x16_bf16 v[176:191], v[164:167], v[172:175], v[176:191]
LS31:
  s_xor_b32 s42, s70, 458752
  buffer_load_dwordx4 v[224:227], v8, s[24:27], s42 offen offset:0 sc1
  buffer_load_dwordx4 v[228:231], v8, s[24:27], s42 offen offset:1024 sc1
  v_exp_f32 v120, v120
  v_cvt_pk_bf16_f32 v139, v118, v119
  v_exp_f32 v121, v121
  v_exp_f32 v122, v122
  v_cvt_pk_bf16_f32 v140, v120, v121
  v_exp_f32 v123, v123
  v_mfma_f32_32x32x16_bf16 v[64:79], v[236:239], v[132:135], v[64:79]
  v_exp_f32 v124, v124
  v_cvt_pk_bf16_f32 v141, v122, v123
  v_exp_f32 v125, v125
  v_exp_f32 v126, v126
  v_cvt_pk_bf16_f32 v142, v124, v125
  v_exp_f32 v127, v127
  v_exp_f32 v96, v96
  v_cvt_pk_bf16_f32 v143, v126, v127
  v_mfma_f32_32x32x16_bf16 v[112:127], v[240:243], v[24:27], 0
  v_exp_f32 v97, v97
  v_exp_f32 v98, v98
  v_cvt_pk_bf16_f32 v128, v96, v97
  v_exp_f32 v99, v99
  v_mfma_f32_32x32x16_bf16 v[112:127], v[244:247], v[28:31], v[112:127]
  v_exp_f32 v100, v100
  v_cvt_pk_bf16_f32 v129, v98, v99
  v_exp_f32 v101, v101
  v_exp_f32 v102, v102
  v_cvt_pk_bf16_f32 v130, v100, v101
  v_exp_f32 v103, v103
  v_mfma_f32_32x32x16_bf16 v[80:95], v[232:235], v[136:139], v[80:95]
  s_cbranch_vccz LS32
  v_add_f32 v15, 897988541, v183
  v_rcp_f32 v15, v15
  s_nop 0
  v_mul_f32 v176, v176, v15
  v_mul_f32 v177, v177, v15
  v_mul_f32 v178, v178, v15
  v_mul_f32 v179, v179, v15
  v_mul_f32 v180, v180, v15
  v_mul_f32 v181, v181, v15
  v_mul_f32 v182, v182, v15
  v_mov_b32 v183, 8388608
  v_mul_f32 v184, v184, v15
  v_mul_f32 v185, v185, v15
  v_mul_f32 v186, v186, v15
  v_mul_f32 v187, v187, v15
  v_mul_f32 v188, v188, v15
  v_mul_f32 v189, v189, v15
  v_mul_f32 v190, v190, v15
  v_mov_b32 v191, 8388608
  v_cvt_pk_bf16_f32 v160, v176, v177
  v_cvt_pk_bf16_f32 v161, v178, v179
  v_cvt_pk_bf16_f32 v162, v180, v181
  v_cvt_pk_bf16_f32 v163, v182, v183
  v_cvt_pk_bf16_f32 v164, v184, v185
  v_cvt_pk_bf16_f32 v165, v186, v187
  v_cvt_pk_bf16_f32 v166, v188, v189
  v_cvt_pk_bf16_f32 v167, v190, v191
  buffer_store_dwordx4 v[160:163], v8, s[24:27], s58 offen offset:0 sc1
  buffer_store_dwordx4 v[164:167], v8, s[24:27], s58 offen offset:1024 sc1
LS32:
  s_xor_b32 s42, s71, 26624
  buffer_load_dwordx4 v[216:219], v5, s[24:27], s42 offen offset:0 sc1
  buffer_load_dwordx4 v[220:223], v5, s[24:27], s42 offen offset:1024 sc1
  s_add_u32 m0, s36, 73728
  s_mov_b32 s43, 172032
  buffer_load_dwordx4 v4, s[16:19], s43 offen lds
  buffer_load_dwordx4 v[32:35], v0, s[24:27], 0 offen sc1
  v_exp_f32 v104, v104
  v_cvt_pk_bf16_f32 v131, v102, v103
  v_exp_f32 v105, v105
  v_exp_f32 v106, v106
  v_cvt_pk_bf16_f32 v132, v104, v105
  v_exp_f32 v107, v107
  v_mfma_f32_32x32x16_bf16 v[80:95], v[236:239], v[140:143], v[80:95]
  v_exp_f32 v108, v108
  v_cvt_pk_bf16_f32 v133, v106, v107
  v_exp_f32 v109, v109
  v_exp_f32 v110, v110
  v_cvt_pk_bf16_f32 v134, v108, v109
  v_exp_f32 v111, v111
  v_exp_f32 v112, v112
  v_cvt_pk_bf16_f32 v135, v110, v111
  s_waitcnt vmcnt(16)
  s_cbranch_vccnz LW33
  s_waitcnt vmcnt(14)
LW33:
  v_mfma_f32_32x32x16_bf16 v[96:111], v[192:195], v[16:19], 0
  v_exp_f32 v113, v113
  v_exp_f32 v114, v114
  v_cvt_pk_bf16_f32 v136, v112, v113
  v_exp_f32 v115, v115
  v_mfma_f32_32x32x16_bf16 v[96:111], v[196:199], v[20:23], v[96:111]
  v_exp_f32 v116, v116
  v_cvt_pk_bf16_f32 v137, v114, v115
  v_exp_f32 v117, v117
  v_exp_f32 v118, v118
  v_cvt_pk_bf16_f32 v138, v116, v117
  v_exp_f32 v119, v119
  s_waitcnt vmcnt(14)
  s_cbranch_vccnz LW34
  s_waitcnt vmcnt(12)
LW34:
  v_mfma_f32_32x32x16_bf16 v[64:79], v[248:251], v[128:131], v[64:79]
  s_xor_b32 s42, s70, 491520
  buffer_load_dwordx4 v[240:243], v8, s[24:27], s42 offen offset:0 sc1
  buffer_load_dwordx4 v[244:247], v8, s[24:27], s42 offen offset:1024 sc1
  v_exp_f32 v120, v120
  v_cvt_pk_bf16_f32 v139, v118, v119
  v_exp_f32 v121, v121
  v_exp_f32 v122, v122
  v_cvt_pk_bf16_f32 v140, v120, v121
  v_exp_f32 v123, v123
  v_mfma_f32_32x32x16_bf16 v[64:79], v[252:255], v[132:135], v[64:79]
  v_exp_f32 v124, v124
  v_cvt_pk_bf16_f32 v141, v122, v123
  v_exp_f32 v125, v125
  v_exp_f32 v126, v126
  v_cvt_pk_bf16_f32 v142, v124, v125
  v_exp_f32 v127, v127
  v_exp_f32 v96, v96
  v_cvt_pk_bf16_f32 v143, v126, v127
  v_mfma_f32_32x32x16_bf16 v[112:127], v[192:195], v[24:27], 0
  v_exp_f32 v97, v97
  v_exp_f32 v98, v98
  v_cvt_pk_bf16_f32 v128, v96, v97
  v_exp_f32 v99, v99
  v_mfma_f32_32x32x16_bf16 v[112:127], v[196:199], v[28:31], v[112:127]
  v_exp_f32 v100, v100
  v_cvt_pk_bf16_f32 v129, v98, v99
  v_exp_f32 v101, v101
  v_exp_f32 v102, v102
  v_cvt_pk_bf16_f32 v130, v100, v101
  v_exp_f32 v103, v103
  v_mfma_f32_32x32x16_bf16 v[80:95], v[248:251], v[136:139], v[80:95]
  s_xor_b32 s42, s71, 28672
  buffer_load_dwordx4 v[232:235], v5, s[24:27], s42 offen offset:0 sc1
  buffer_load_dwordx4 v[236:239], v5, s[24:27], s42 offen offset:1024 sc1
  s_add_u32 m0, s36, 81920
  s_mov_b32 s43, 229376
  buffer_load_dwordx4 v4, s[16:19], s43 offen lds
  v_exp_f32 v104, v104
  v_cvt_pk_bf16_f32 v131, v102, v103
  v_exp_f32 v105, v105
  v_exp_f32 v106, v106
  v_cvt_pk_bf16_f32 v132, v104, v105
  v_exp_f32 v107, v107
  v_mfma_f32_32x32x16_bf16 v[80:95], v[252:255], v[140:143], v[80:95]
  v_exp_f32 v108, v108
  v_cvt_pk_bf16_f32 v133, v106, v107
  v_exp_f32 v109, v109
  v_exp_f32 v110, v110
  v_cvt_pk_bf16_f32 v134, v108, v109
  v_exp_f32 v111, v111
  v_exp_f32 v112, v112
  v_cvt_pk_bf16_f32 v135, v110, v111
  s_waitcnt vmcnt(16)
  s_cbranch_vccnz LW35
  s_waitcnt vmcnt(14)
LW35:
  v_mfma_f32_32x32x16_bf16 v[96:111], v[208:211], v[16:19], 0
  v_exp_f32 v113, v113
  v_exp_f32 v114, v114
  v_cvt_pk_bf16_f32 v136, v112, v113
  v_exp_f32 v115, v115
  v_mfma_f32_32x32x16_bf16 v[96:111], v[212:215], v[20:23], v[96:111]
  v_exp_f32 v116, v116
  v_cvt_pk_bf16_f32 v137, v114, v115
  v_exp_f32 v117, v117
  v_exp_f32 v118, v118
  v_cvt_pk_bf16_f32 v138, v116, v117
  v_exp_f32 v119, v119
  s_waitcnt vmcnt(14)
  s_cbranch_vccnz LW36
  s_waitcnt vmcnt(12)
LW36:
  v_mfma_f32_32x32x16_bf16 v[64:79], v[200:203], v[128:131], v[64:79]
  v_exp_f32 v120, v120
  v_cvt_pk_bf16_f32 v139, v118, v119
  v_exp_f32 v121, v121
  v_exp_f32 v122, v122
  v_cvt_pk_bf16_f32 v140, v120, v121
  v_exp_f32 v123, v123
  v_mfma_f32_32x32x16_bf16 v[64:79], v[204:207], v[132:135], v[64:79]
  v_exp_f32 v124, v124
  v_cvt_pk_bf16_f32 v141, v122, v123
  v_exp_f32 v125, v125
  v_exp_f32 v126, v126
  v_cvt_pk_bf16_f32 v142, v124, v125
  v_exp_f32 v127, v127
  s_setprio 1
  v_exp_f32 v96, v96
  v_cvt_pk_bf16_f32 v143, v126, v127
  v_mfma_f32_32x32x16_bf16 v[112:127], v[208:211], v[24:27], 0
  v_exp_f32 v97, v97
  v_exp_f32 v98, v98
  v_cvt_pk_bf16_f32 v128, v96, v97
  v_exp_f32 v99, v99
  v_mfma_f32_32x32x16_bf16 v[112:127], v[212:215], v[28:31], v[112:127]
  v_exp_f32 v100, v100
  v_cvt_pk_bf16_f32 v129, v98, v99
  v_exp_f32 v101, v101
  v_exp_f32 v102, v102
  v_cvt_pk_bf16_f32 v130, v100, v101
  v_exp_f32 v103, v103
  v_mfma_f32_32x32x16_bf16 v[80:95], v[200:203], v[136:139], v[80:95]
  s_xor_b32 s42, s71, 30720
  buffer_load_dwordx4 v[248:251], v5, s[24:27], s42 offen offset:0 sc1
  buffer_load_dwordx4 v[252:255], v5, s[24:27], s42 offen offset:1024 sc1
  s_add_u32 m0, s36, 90112
  s_mov_b32 s43, 286720
  buffer_load_dwordx4 v4, s[16:19], s43 offen lds
  v_exp_f32 v104, v104
  v_cvt_pk_bf16_f32 v131, v102, v103
  v_exp_f32 v105, v105
  v_exp_f32 v106, v106
  v_cvt_pk_bf16_f32 v132, v104, v105
  v_exp_f32 v107, v107
  v_mfma_f32_32x32x16_bf16 v[80:95], v[204:207], v[140:143], v[80:95]
  v_exp_f32 v108, v108
  v_cvt_pk_bf16_f32 v133, v106, v107
  v_exp_f32 v109, v109
  v_exp_f32 v110, v110
  v_cvt_pk_bf16_f32 v134, v108, v109
  v_exp_f32 v111, v111
  v_exp_f32 v112, v112
  v_cvt_pk_bf16_f32 v135, v110, v111
  s_waitcnt vmcnt(14)
  s_cbranch_vccnz LW37
  s_waitcnt vmcnt(12)
LW37:
  v_mfma_f32_32x32x16_bf16 v[96:111], v[224:227], v[16:19], 0
  v_exp_f32 v113, v113
  v_exp_f32 v114, v114
  v_cvt_pk_bf16_f32 v136, v112, v113
  v_exp_f32 v115, v115
  v_mfma_f32_32x32x16_bf16 v[96:111], v[228:231], v[20:23], v[96:111]
  v_exp_f32 v116, v116
  v_cvt_pk_bf16_f32 v137, v114, v115
  v_exp_f32 v117, v117
  v_exp_f32 v118, v118
  v_cvt_pk_bf16_f32 v138, v116, v117
  v_exp_f32 v119, v119
  s_waitcnt vmcnt(10)
  v_mfma_f32_32x32x16_bf16 v[64:79], v[216:219], v[128:131], v[64:79]
  v_exp_f32 v120, v120
  v_cvt_pk_bf16_f32 v139, v118, v119
  v_exp_f32 v121, v121
  v_exp_f32 v122, v122
  v_cvt_pk_bf16_f32 v140, v120, v121
  v_exp_f32 v123, v123
  v_mfma_f32_32x32x16_bf16 v[64:79], v[220:223], v[132:135], v[64:79]
  v_exp_f32 v124, v124
  v_cvt_pk_bf16_f32 v141, v122, v123
  v_exp_f32 v125, v125
  v_exp_f32 v126, v126
  v_cvt_pk_bf16_f32 v142, v124, v125
  v_exp_f32 v127, v127
  v_exp_f32 v96, v96
  v_cvt_pk_bf16_f32 v143, v126, v127
  v_mfma_f32_32x32x16_bf16 v[112:127], v[224:227], v[24:27], 0
  v_exp_f32 v97, v97
  v_exp_f32 v98, v98
  v_cvt_pk_bf16_f32 v128, v96, v97
  v_exp_f32 v99, v99
  v_mfma_f32_32x32x16_bf16 v[112:127], v[228:231], v[28:31], v[112:127]
  v_exp_f32 v100, v100
  v_cvt_pk_bf16_f32 v129, v98, v99
  v_exp_f32 v101, v101
  v_exp_f32 v102, v102
  v_cvt_pk_bf16_f32 v130, v100, v101
  v_exp_f32 v103, v103
  v_mfma_f32_32x32x16_bf16 v[80:95], v[216:219], v[136:139], v[80:95]
  s_add_u32 m0, s36, 98304
  s_mov_b32 s43, 344064
  buffer_load_dwordx4 v4, s[16:19], s43 offen lds
  v_exp_f32 v104, v104
  v_cvt_pk_bf16_f32 v131, v102, v103
  v_exp_f32 v105, v105
  v_exp_f32 v106, v106
  v_cvt_pk_bf16_f32 v132, v104, v105
  v_exp_f32 v107, v107
  v_mfma_f32_32x32x16_bf16 v[80:95], v[220:223], v[140:143], v[80:95]
  v_exp_f32 v108, v108
  v_cvt_pk_bf16_f32 v133, v106, v107
  v_exp_f32 v109, v109
  v_exp_f32 v110, v110
  v_cvt_pk_bf16_f32 v134, v108, v109
  v_exp_f32 v111, v111
  v_exp_f32 v112, v112
  v_cvt_pk_bf16_f32 v135, v110, v111
  s_waitcnt vmcnt(7)
  v_mfma_f32_32x32x16_bf16 v[96:111], v[240:243], v[16:19], 0
  v_exp_f32 v113, v113
  v_exp_f32 v114, v114
  v_cvt_pk_bf16_f32 v136, v112, v113
  v_exp_f32 v115, v115
  v_mfma_f32_32x32x16_bf16 v[96:111], v[244:247], v[20:23], v[96:111]
  v_exp_f32 v116, v116
  v_cvt_pk_bf16_f32 v137, v114, v115
  v_exp_f32 v117, v117
  v_exp_f32 v118, v118
  v_cvt_pk_bf16_f32 v138, v116, v117
  v_exp_f32 v119, v119
  s_waitcnt vmcnt(5)
  v_mfma_f32_32x32x16_bf16 v[64:79], v[232:235], v[128:131], v[64:79]
  v_exp_f32 v120, v120
  v_cvt_pk_bf16_f32 v139, v118, v119
  v_exp_f32 v121, v121
  v_exp_f32 v122, v122
  v_cvt_pk_bf16_f32 v140, v120, v121
  v_exp_f32 v123, v123
  v_mfma_f32_32x32x16_bf16 v[64:79], v[236:239], v[132:135], v[64:79]
  v_exp_f32 v124, v124
  v_cvt_pk_bf16_f32 v141, v122, v123
  v_exp_f32 v125, v125
  v_exp_f32 v126, v126
  v_cvt_pk_bf16_f32 v142, v124, v125
  v_exp_f32 v127, v127
  s_setprio 0
  v_exp_f32 v96, v96
  v_cvt_pk_bf16_f32 v143, v126, v127
  v_mfma_f32_32x32x16_bf16 v[112:127], v[240:243], v[24:27], 0
  v_exp_f32 v97, v97
  v_exp_f32 v98, v98
  v_cvt_pk_bf16_f32 v128, v96, v97
  v_exp_f32 v99, v99
  v_mfma_f32_32x32x16_bf16 v[112:127], v[244:247], v[28:31], v[112:127]
  v_exp_f32 v100, v100
  v_cvt_pk_bf16_f32 v129, v98, v99
  v_exp_f32 v101, v101
  v_exp_f32 v102, v102
  v_cvt_pk_bf16_f32 v130, v100, v101
  v_exp_f32 v103, v103
  v_mfma_f32_32x32x16_bf16 v[80:95], v[232:235], v[136:139], v[80:95]
  s_mov_b32 s52, 20000
LP38:
  v_cmp_ne_u64 s[48:49], s[50:51], v[32:33]
  v_cmp_ne_u64 s[34:35], s[50:51], v[34:35]
  s_nop 0
  s_or_b64 s[48:49], s[48:49], s[34:35]
  s_cmp_eq_u64 s[48:49], 0
  s_cbranch_scc1 LD39
  s_sub_u32 s52, s52, 1
  s_cbranch_scc1 LD39
  s_sleep 4
  buffer_load_dwordx4 v[32:35], v0, s[24:27], 0 offen sc1
  s_waitcnt vmcnt(0)
  s_branch LP38
LD39:
  v_exp_f32 v104, v104
  v_cvt_pk_bf16_f32 v131, v102, v103
  v_exp_f32 v105, v105
  v_exp_f32 v106, v106
  v_cvt_pk_bf16_f32 v132, v104, v105
  v_exp_f32 v107, v107
  v_mfma_f32_32x32x16_bf16 v[80:95], v[236:239], v[140:143], v[80:95]
  v_exp_f32 v108, v108
  v_cvt_pk_bf16_f32 v133, v106, v107
  v_exp_f32 v109, v109
  v_exp_f32 v110, v110
  v_cvt_pk_bf16_f32 v134, v108, v109
  v_exp_f32 v111, v111
  v_exp_f32 v112, v112
  v_cvt_pk_bf16_f32 v135, v110, v111
  v_exp_f32 v113, v113
  v_exp_f32 v114, v114
  v_cvt_pk_bf16_f32 v136, v112, v113
  v_exp_f32 v115, v115
  v_exp_f32 v116, v116
  v_cvt_pk_bf16_f32 v137, v114, v115
  v_exp_f32 v117, v117
  v_exp_f32 v118, v118
  v_cvt_pk_bf16_f32 v138, v116, v117
  v_exp_f32 v119, v119
  s_waitcnt vmcnt(2)
  v_mfma_f32_32x32x16_bf16 v[64:79], v[248:251], v[128:131], v[64:79]
  v_exp_f32 v120, v120
  v_cvt_pk_bf16_f32 v139, v118, v119
  v_exp_f32 v121, v121
  v_exp_f32 v122, v122
  v_cvt_pk_bf16_f32 v140, v120, v121
  v_exp_f32 v123, v123
  v_mfma_f32_32x32x16_bf16 v[64:79], v[252:255], v[132:135], v[64:79]
  v_exp_f32 v124, v124
  v_cvt_pk_bf16_f32 v141, v122, v123
  v_exp_f32 v125, v125
  v_exp_f32 v126, v126
  v_cvt_pk_bf16_f32 v142, v124, v125
  v_exp_f32 v127, v127
  s_nop 0
  v_cvt_pk_bf16_f32 v143, v126, v127
  s_nop 1
  v_mfma_f32_32x32x16_bf16 v[80:95], v[248:251], v[136:139], v[80:95]
  v_mfma_f32_32x32x16_bf16 v[80:95], v[252:255], v[140:143], v[80:95]
L_TAIL:
  s_lshl_b32 s33, s61, 2
  s_lshr_b32 s32, s31, 1
  v_lshrrev_b32 v6, 5, v1
  v_bfe_u32 v7, v1, 2, 2
  v_lshl_add_u32 v11, v6, 2, v7
  v_min_u32 v7, 2, v7
  v_mad_u32_u24 v12, v6, 3, v7
  v_add_u32 v12, 8, v12
  v_bfe_u32 v5, v1, 4, 1
  v_lshlrev_b32 v5, 5, v5
  v_and_b32 v7, 3, v1
  v_lshl_add_u32 v5, v7, 3, v5
  s_mul_i32 s34, s32, 14336
  s_add_u32 s34, s34, 106496
  v_add_u32 v5, s34, v5
  v_bfe_u32 v7, v11, 1, 1
  v_lshl_add_u32 v240, v11, 7, v5
  v_lshl_add_u32 v240, v7, 6, v240
  v_xor_b32 v244, 64, v240
  v_bfe_u32 v7, v12, 1, 1
  v_lshl_add_u32 v241, v12, 7, v5
  v_lshl_add_u32 v241, v7, 6, v241
  v_xor_b32 v245, 64, v241
  v_add_u32 v11, 14, v11
  v_bfe_u32 v7, v11, 1, 1
  v_lshl_add_u32 v242, v11, 7, v5
  v_lshl_add_u32 v242, v7, 6, v242
  v_xor_b32 v246, 64, v242
  v_add_u32 v12, 14, v12
  v_bfe_u32 v7, v12, 1, 1
  v_lshl_add_u32 v243, v12, 7, v5
  v_lshl_add_u32 v243, v7, 6, v243
  v_xor_b32 v247, 64, v243
  s_sub_u32 s34, s60, 1
  s_and_b32 s34, s34, 3
  s_cmp_eq_u32 s34, 3
  s_cbranch_scc1 LR40
  s_lshl_b32 s34, s34, 11
  s_mul_i32 s35, s33, 6144
  s_add_u32 s34, s34, s35
  s_add_u32 s34, s34, 0
  v_add_u32 v10, s34, v8
  ds_write_b128 v10, v[64:67]
  ds_write_b128 v10, v[68:71] offset:1024
  s_branch LR41
LR40:
  v_mov_b32 v96, v64
  v_mov_b32 v97, v65
  v_mov_b32 v98, v66
  v_mov_b32 v99, v67
  v_mov_b32 v100, v68
  v_mov_b32 v101, v69
  v_mov_b32 v102, v70
  v_mov_b32 v103, v71
LR41:
  s_sub_u32 s34, s60, 2
  s_and_b32 s34, s34, 3
  s_cmp_eq_u32 s34, 3
  s_cbranch_scc1 LR42
  s_lshl_b32 s34, s34, 11
  s_mul_i32 s35, s33, 6144
  s_add_u32 s34, s34, s35
  s_add_u32 s34, s34, 6144
  v_add_u32 v10, s34, v8
  ds_write_b128 v10, v[72:75]
  ds_write_b128 v10, v[76:79] offset:1024
  s_branch LR43
LR42:
  v_mov_b32 v96, v72
  v_mov_b32 v97, v73
  v_mov_b32 v98, v74
  v_mov_b32 v99, v75
  v_mov_b32 v100, v76
  v_mov_b32 v101, v77
  v_mov_b32 v102, v78
  v_mov_b32 v103, v79
LR43:
  s_sub_u32 s34, s60, 3
  s_and_b32 s34, s34, 3
  s_cmp_eq_u32 s34, 3
  s_cbranch_scc1 LR44
  s_lshl_b32 s34, s34, 11
  s_mul_i32 s35, s33, 6144
  s_add_u32 s34, s34, s35
  s_add_u32 s34, s34, 12288
  v_add_u32 v10, s34, v8
  ds_write_b128 v10, v[80:83]
  ds_write_b128 v10, v[84:87] offset:1024
  s_branch LR45
LR44:
  v_mov_b32 v96, v80
  v_mov_b32 v97, v81
  v_mov_b32 v98, v82
  v_mov_b32 v99, v83
  v_mov_b32 v100, v84
  v_mov_b32 v101, v85
  v_mov_b32 v102, v86
  v_mov_b32 v103, v87
LR45:
  s_sub_u32 s34, s60, 4
  s_and_b32 s34, s34, 3
  s_cmp_eq_u32 s34, 3
  s_cbranch_scc1 LR46
  s_lshl_b32 s34, s34, 11
  s_mul_i32 s35, s33, 6144
  s_add_u32 s34, s34, s35
  s_add_u32 s34, s34, 18432
  v_add_u32 v10, s34, v8
  ds_write_b128 v10, v[88:91]
  ds_write_b128 v10, v[92:95] offset:1024
  s_branch LR47
LR46:
  v_mov_b32 v96, v88
  v_mov_b32 v97, v89
  v_mov_b32 v98, v90
  v_mov_b32 v99, v91
  v_mov_b32 v100, v92
  v_mov_b32 v101, v93
  v_mov_b32 v102, v94
  v_mov_b32 v103, v95
LR47:
  s_lshl_b32 s34, s53, 1
  s_add_u32 s34, s34, s57
  s_lshl_b32 s34, s34, 5
  v_and_b32 v5, 31, v1
  v_add_u32 v5, s34, v5
  v_mul_u32_u24 v5, 1792, v5
  v_lshl_add_u32 v248, v6, 4, v5
  s_lshl_b32 s70, s54, 7
  s_lshl_b32 s34, s32, 5
  s_add_u32 s70, s70, s34
  s_add_u32 s71, s70, 896
  s_mov_b32 s44, s64
  s_and_b32 s45, s65, 0xffff
  s_mov_b32 s46, 3670016
  s_mov_b32 s47, 0x20000
  s_lshl_b32 s62, s53, 1
  s_add_u32 s62, s62, s57
  s_lshl_b32 s62, s62, 2
  s_lshr_b32 s63, s31, 1
  s_add_u32 s62, s62, s63
  s_lshl_b32 s62, s62, 13
  s_add_u32 s62, s62, 14680064
  s_add_u32 s63, s62, 4096
  buffer_load_dwordx4 v[144:147], v8, s[24:27], s62 offen offset:0 sc1
  buffer_load_dwordx4 v[148:151], v8, s[24:27], s62 offen offset:1024 sc1
  buffer_load_dwordx4 v[152:155], v8, s[24:27], s62 offen offset:2048 sc1
  buffer_load_dwordx4 v[156:159], v8, s[24:27], s62 offen offset:3072 sc1
  buffer_load_dwordx4 v[160:163], v8, s[24:27], s63 offen offset:0 sc1
  buffer_load_dwordx4 v[164:167], v8, s[24:27], s63 offen offset:1024 sc1
  buffer_load_dwordx4 v[168:171], v8, s[24:27], s63 offen offset:2048 sc1
  buffer_load_dwordx4 v[172:175], v8, s[24:27], s63 offen offset:3072 sc1
  s_waitcnt vmcnt(8) lgkmcnt(0)
  s_barrier
  s_mul_i32 s34, s31, 6144
  s_add_u32 s34, s34, 0
  v_add_u32 v10, s34, v8
  ds_read_b128 v[104:107], v10 offset:0
  ds_read_b128 v[108:111], v10 offset:1024
  ds_read_b128 v[112:115], v10 offset:2048
  ds_read_b128 v[116:119], v10 offset:3072
  ds_read_b128 v[120:123], v10 offset:4096
  ds_read_b128 v[124:127], v10 offset:5120
  s_waitcnt lgkmcnt(2)
  v_add_f32 v96, v96, v104
  v_add_f32 v97, v97, v105
  v_add_f32 v98, v98, v106
  v_add_f32 v99, v99, v107
  v_add_f32 v100, v100, v108
  v_add_f32 v101, v101, v109
  v_add_f32 v102, v102, v110
  v_add_f32 v103, v103, v111
  s_waitcnt lgkmcnt(0)
  v_add_f32 v112, v112, v120
  v_add_f32 v113, v113, v121
  v_add_f32 v114, v114, v122
  v_add_f32 v115, v115, v123
  v_add_f32 v116, v116, v124
  v_add_f32 v117, v117, v125
  v_add_f32 v118, v118, v126
  v_add_f32 v119, v119, v127
  v_add_f32 v96, v96, v112
  v_add_f32 v97, v97, v113
  v_add_f32 v98, v98, v114
  v_add_f32 v99, v99, v115
  v_add_f32 v100, v100, v116
  v_add_f32 v101, v101, v117
  v_add_f32 v102, v102, v118
  v_add_f32 v103, v103, v119
  v_rcp_f32 v11, v103
  s_nop 0
  v_mul_f32 v96, v96, v11
  v_mul_f32 v97, v97, v11
  v_mul_f32 v98, v98, v11
  v_mul_f32 v99, v99, v11
  v_mul_f32 v100, v100, v11
  v_mul_f32 v101, v101, v11
  v_mul_f32 v102, v102, v11
  v_mov_b32 v103, 8388608
  v_cvt_pk_bf16_f32 v104, v96, v97
  v_cvt_pk_bf16_f32 v105, v98, v99
  v_cvt_pk_bf16_f32 v106, v100, v101
  v_cvt_pk_bf16_f32 v107, v102, v103
  buffer_store_dwordx4 v[104:107], v8, s[24:27], s59 offen sc1
  s_cmp_ge_u32 s30, 28
  s_cbranch_scc1 L_FIN
  s_mov_b32 s42, 8388608
  ds_read_b64_tr_b16 v[224:225], v240 offset:0
  ds_read_b64_tr_b16 v[226:227], v241 offset:0
  ds_read_b64_tr_b16 v[228:229], v244 offset:0
  ds_read_b64_tr_b16 v[230:231], v245 offset:0
  s_waitcnt vmcnt(1)
  s_mov_b32 s52, 20000
LP48:
  v_min3_u32 v11, v147, v151, v155
  v_min3_u32 v12, v159, v163, v167
  v_min3_u32 v11, v11, v171, v175
  v_min_u32 v11, v11, v12
  v_cmp_gt_u32 s[48:49], s42, v11
  s_nop 0
  s_cmp_eq_u64 s[48:49], 0
  s_cbranch_scc1 LD49
  s_sub_u32 s52, s52, 1
  s_cbranch_scc1 LD49
  s_sleep 4
  buffer_load_dwordx4 v[144:147], v8, s[24:27], s62 offen offset:0 sc1
  buffer_load_dwordx4 v[148:151], v8, s[24:27], s62 offen offset:1024 sc1
  buffer_load_dwordx4 v[152:155], v8, s[24:27], s62 offen offset:2048 sc1
  buffer_load_dwordx4 v[156:159], v8, s[24:27], s62 offen offset:3072 sc1
  buffer_load_dwordx4 v[160:163], v8, s[24:27], s63 offen offset:0 sc1
  buffer_load_dwordx4 v[164:167], v8, s[24:27], s63 offen offset:1024 sc1
  buffer_load_dwordx4 v[168:171], v8, s[24:27], s63 offen offset:2048 sc1
  buffer_load_dwordx4 v[172:175], v8, s[24:27], s63 offen offset:3072 sc1
  s_waitcnt vmcnt(0)
  s_branch LP48
LD49:
  ds_read_b64_tr_b16 v[232:233], v242 offset:0
  ds_read_b64_tr_b16 v[234:235], v243 offset:0
  ds_read_b64_tr_b16 v[236:237], v246 offset:0
  ds_read_b64_tr_b16 v[238:239], v247 offset:0
  s_waitcnt lgkmcnt(4)
  v_mfma_f32_32x32x16_bf16 v[32:47], v[224:227], v[144:147], 0
  v_mfma_f32_32x32x16_bf16 v[48:63], v[228:231], v[144:147], 0
  ds_read_b64_tr_b16 v[224:225], v240 offset:3584
  ds_read_b64_tr_b16 v[226:227], v241 offset:3584
  ds_read_b64_tr_b16 v[228:229], v244 offset:3584
  ds_read_b64_tr_b16 v[230:231], v245 offset:3584
  s_waitcnt lgkmcnt(4)
  v_mfma_f32_32x32x16_bf16 v[32:47], v[232:235], v[148:151], v[32:47]
  v_mfma_f32_32x32x16_bf16 v[48:63], v[236:239], v[148:151], v[48:63]
  ds_read_b64_tr_b16 v[232:233], v242 offset:3584
  ds_read_b64_tr_b16 v[234:235], v243 offset:3584
  ds_read_b64_tr_b16 v[236:237], v246 offset:3584
  ds_read_b64_tr_b16 v[238:239], v247 offset:3584
  s_waitcnt lgkmcnt(4)
  v_mfma_f32_32x32x16_bf16 v[32:47], v[224:227], v[152:155], v[32:47]
  v_mfma_f32_32x32x16_bf16 v[48:63], v[228:231], v[152:155], v[48:63]
  ds_read_b64_tr_b16 v[224:225], v240 offset:7168
  ds_read_b64_tr_b16 v[226:227], v241 offset:7168
  ds_read_b64_tr_b16 v[228:229], v244 offset:7168
  ds_read_b64_tr_b16 v[230:231], v245 offset:7168
  s_waitcnt lgkmcnt(4)
  v_mfma_f32_32x32x16_bf16 v[32:47], v[232:235], v[156:159], v[32:47]
  v_mfma_f32_32x32x16_bf16 v[48:63], v[236:239], v[156:159], v[48:63]
  ds_read_b64_tr_b16 v[232:233], v242 offset:7168
  ds_read_b64_tr_b16 v[234:235], v243 offset:7168
  ds_read_b64_tr_b16 v[236:237], v246 offset:7168
  ds_read_b64_tr_b16 v[238:239], v247 offset:7168
  s_waitcnt lgkmcnt(4)
  v_mfma_f32_32x32x16_bf16 v[32:47], v[224:227], v[160:163], v[32:47]
  v_mfma_f32_32x32x16_bf16 v[48:63], v[228:231], v[160:163], v[48:63]
  ds_read_b64_tr_b16 v[224:225], v240 offset:10752
  ds_read_b64_tr_b16 v[226:227], v241 offset:10752
  ds_read_b64_tr_b16 v[228:229], v244 offset:10752
  ds_read_b64_tr_b16 v[230:231], v245 offset:10752
  s_waitcnt lgkmcnt(4)
  v_mfma_f32_32x32x16_bf16 v[32:47], v[232:235], v[164:167], v[32:47]
  v_mfma_f32_32x32x16_bf16 v[48:63], v[236:239], v[164:167], v[48:63]
  ds_read_b64_tr_b16 v[232:233], v242 offset:10752
  ds_read_b64_tr_b16 v[234:235], v243 offset:10752
  ds_read_b64_tr_b16 v[236:237], v246 offset:10752
  ds_read_b64_tr_b16 v[238:239], v247 offset:10752
  s_waitcnt lgkmcnt(4)
  v_mfma_f32_32x32x16_bf16 v[32:47], v[224:227], v[168:171], v[32:47]
  v_mfma_f32_32x32x16_bf16 v[48:63], v[228:231], v[168:171], v[48:63]
  s_waitcnt lgkmcnt(0)
  v_mfma_f32_32x32x16_bf16 v[32:47], v[232:235], v[172:175], v[32:47]
  v_mfma_f32_32x32x16_bf16 v[48:63], v[236:239], v[172:175], v[48:63]
  s_lshl_b32 s62, s53, 1
  s_add_u32 s62, s62, s57
  s_lshl_b32 s62, s62, 2
  s_lshr_b32 s63, s31, 1
  s_add_u32 s62, s62, s63
  s_lshl_b32 s62, s62, 13
  s_add_u32 s62, s62, 12582912
  s_add_u32 s63, s62, 4096
  v_subrev_u32 v240, 57344, v240
  v_subrev_u32 v241, 57344, v241
  v_subrev_u32 v242, 57344, v242
  v_subrev_u32 v243, 57344, v243
  v_subrev_u32 v244, 57344, v244
  v_subrev_u32 v245, 57344, v245
  v_subrev_u32 v246, 57344, v246
  v_subrev_u32 v247, 57344, v247
  s_barrier
  s_sub_u32 s34, s32, 1
  s_and_b32 s34, s34, 3
  s_cmp_eq_u32 s34, 3
  s_cbranch_scc1 LR50
  s_lshl_b32 s34, s34, 11
  s_mul_i32 s35, s57, 6144
  s_add_u32 s34, s34, s35
  s_add_u32 s34, s34, 0
  v_add_u32 v10, s34, v8
  ds_write_b128 v10, v[32:35]
  ds_write_b128 v10, v[36:39] offset:1024
  s_branch LR51
LR50:
  v_mov_b32 v96, v32
  v_mov_b32 v97, v33
  v_mov_b32 v98, v34
  v_mov_b32 v99, v35
  v_mov_b32 v100, v36
  v_mov_b32 v101, v37
  v_mov_b32 v102, v38
  v_mov_b32 v103, v39
LR51:
  s_sub_u32 s34, s32, 2
  s_and_b32 s34, s34, 3
  s_cmp_eq_u32 s34, 3
  s_cbranch_scc1 LR52
  s_lshl_b32 s34, s34, 11
  s_mul_i32 s35, s57, 6144
  s_add_u32 s34, s34, s35
  s_add_u32 s34, s34, 12288
  v_add_u32 v10, s34, v8
  ds_write_b128 v10, v[40:43]
  ds_write_b128 v10, v[44:47] offset:1024
  s_branch LR53
LR52:
  v_mov_b32 v96, v40
  v_mov_b32 v97, v41
  v_mov_b32 v98, v42
  v_mov_b32 v99, v43
  v_mov_b32 v100, v44
  v_mov_b32 v101, v45
  v_mov_b32 v102, v46
  v_mov_b32 v103, v47
LR53:
  s_sub_u32 s34, s32, 3
  s_and_b32 s34, s34, 3
  s_cmp_eq_u32 s34, 3
  s_cbranch_scc1 LR54
  s_lshl_b32 s34, s34, 11
  s_mul_i32 s35, s57, 6144
  s_add_u32 s34, s34, s35
  s_add_u32 s34, s34, 24576
  v_add_u32 v10, s34, v8
  ds_write_b128 v10, v[48:51]
  ds_write_b128 v10, v[52:55] offset:1024
  s_branch LR55
LR54:
  v_mov_b32 v96, v48
  v_mov_b32 v97, v49
  v_mov_b32 v98, v50
  v_mov_b32 v99, v51
  v_mov_b32 v100, v52
  v_mov_b32 v101, v53
  v_mov_b32 v102, v54
  v_mov_b32 v103, v55
LR55:
  s_sub_u32 s34, s32, 4
  s_and_b32 s34, s34, 3
  s_cmp_eq_u32 s34, 3
  s_cbranch_scc1 LR56
  s_lshl_b32 s34, s34, 11
  s_mul_i32 s35, s57, 6144
  s_add_u32 s34, s34, s35
  s_add_u32 s34, s34, 36864
  v_add_u32 v10, s34, v8
  ds_write_b128 v10, v[56:59]
  ds_write_b128 v10, v[60:63] offset:1024
  s_branch LR57
LR56:
  v_mov_b32 v96, v56
  v_mov_b32 v97, v57
  v_mov_b32 v98, v58
  v_mov_b32 v99, v59
  v_mov_b32 v100, v60
  v_mov_b32 v101, v61
  v_mov_b32 v102, v62
  v_mov_b32 v103, v63
LR57:
  buffer_load_dwordx4 v[192:195], v8, s[24:27], s62 offen offset:0 sc1
  buffer_load_dwordx4 v[196:199], v8, s[24:27], s62 offen offset:1024 sc1
  buffer_load_dwordx4 v[200:203], v8, s[24:27], s62 offen offset:2048 sc1
  buffer_load_dwordx4 v[204:207], v8, s[24:27], s62 offen offset:3072 sc1
  buffer_load_dwordx4 v[208:211], v8, s[24:27], s63 offen offset:0 sc1
  buffer_load_dwordx4 v[212:215], v8, s[24:27], s63 offen offset:1024 sc1
  buffer_load_dwordx4 v[216:219], v8, s[24:27], s63 offen offset:2048 sc1
  buffer_load_dwordx4 v[220:223], v8, s[24:27], s63 offen offset:3072 sc1
  s_waitcnt lgkmcnt(0)
  s_barrier
  s_mul_i32 s34, s31, 6144
  s_add_u32 s34, s34, 0
  v_add_u32 v10, s34, v8
  ds_read_b128 v[104:107], v10 offset:0
  ds_read_b128 v[108:111], v10 offset:1024
  ds_read_b128 v[112:115], v10 offset:2048
  ds_read_b128 v[116:119], v10 offset:3072
  ds_read_b128 v[120:123], v10 offset:4096
  ds_read_b128 v[124:127], v10 offset:5120
  s_waitcnt lgkmcnt(2)
  v_add_f32 v96, v96, v104
  v_add_f32 v97, v97, v105
  v_add_f32 v98, v98, v106
  v_add_f32 v99, v99, v107
  v_add_f32 v100, v100, v108
  v_add_f32 v101, v101, v109
  v_add_f32 v102, v102, v110
  v_add_f32 v103, v103, v111
  s_waitcnt lgkmcnt(0)
  v_add_f32 v112, v112, v120
  v_add_f32 v113, v113, v121
  v_add_f32 v114, v114, v122
  v_add_f32 v115, v115, v123
  v_add_f32 v116, v116, v124
  v_add_f32 v117, v117, v125
  v_add_f32 v118, v118, v126
  v_add_f32 v119, v119, v127
  v_add_f32 v96, v96, v112
  v_add_f32 v97, v97, v113
  v_add_f32 v98, v98, v114
  v_add_f32 v99, v99, v115
  v_add_f32 v100, v100, v116
  v_add_f32 v101, v101, v117
  v_add_f32 v102, v102, v118
  v_add_f32 v103, v103, v119
  v_cvt_pk_bf16_f32 v104, v96, v97
  v_cvt_pk_bf16_f32 v105, v98, v99
  v_cvt_pk_bf16_f32 v106, v100, v101
  v_cvt_pk_bf16_f32 v107, v102, v103
  s_nop 1
  v_permlane32_swap_b32 v104, v106
  v_permlane32_swap_b32 v105, v107
  buffer_store_dwordx4 v[104:107], v248, s[44:47], s71 offen
  ds_read_b64_tr_b16 v[224:225], v240 offset:0
  ds_read_b64_tr_b16 v[226:227], v241 offset:0
  ds_read_b64_tr_b16 v[228:229], v244 offset:0
  ds_read_b64_tr_b16 v[230:231], v245 offset:0
  s_waitcnt vmcnt(1)
  s_mov_b32 s52, 20000
LP58:
  v_min3_u32 v11, v195, v199, v203
  v_min3_u32 v12, v207, v211, v215
  v_min3_u32 v11, v11, v219, v223
  v_min_u32 v11, v11, v12
  v_cmp_gt_u32 s[48:49], s42, v11
  s_nop 0
  s_cmp_eq_u64 s[48:49], 0
  s_cbranch_scc1 LD59
  s_sub_u32 s52, s52, 1
  s_cbranch_scc1 LD59
  s_sleep 4
  buffer_load_dwordx4 v[192:195], v8, s[24:27], s62 offen offset:0 sc1
  buffer_load_dwordx4 v[196:199], v8, s[24:27], s62 offen offset:1024 sc1
  buffer_load_dwordx4 v[200:203], v8, s[24:27], s62 offen offset:2048 sc1
  buffer_load_dwordx4 v[204:207], v8, s[24:27], s62 offen offset:3072 sc1
  buffer_load_dwordx4 v[208:211], v8, s[24:27], s63 offen offset:0 sc1
  buffer_load_dwordx4 v[212:215], v8, s[24:27], s63 offen offset:1024 sc1
  buffer_load_dwordx4 v[216:219], v8, s[24:27], s63 offen offset:2048 sc1
  buffer_load_dwordx4 v[220:223], v8, s[24:27], s63 offen offset:3072 sc1
  s_waitcnt vmcnt(0)
  s_branch LP58
LD59:
  ds_read_b64_tr_b16 v[232:233], v242 offset:0
  ds_read_b64_tr_b16 v[234:235], v243 offset:0
  ds_read_b64_tr_b16 v[236:237], v246 offset:0
  ds_read_b64_tr_b16 v[238:239], v247 offset:0
  s_waitcnt lgkmcnt(4)
  v_mfma_f32_32x32x16_bf16 v[32:47], v[224:227], v[192:195], 0
  v_mfma_f32_32x32x16_bf16 v[48:63], v[228:231], v[192:195], 0
  ds_read_b64_tr_b16 v[224:225], v240 offset:3584
  ds_read_b64_tr_b16 v[226:227], v241 offset:3584
  ds_read_b64_tr_b16 v[228:229], v244 offset:3584
  ds_read_b64_tr_b16 v[230:231], v245 offset:3584
  s_waitcnt lgkmcnt(4)
  v_mfma_f32_32x32x16_bf16 v[32:47], v[232:235], v[196:199], v[32:47]
  v_mfma_f32_32x32x16_bf16 v[48:63], v[236:239], v[196:199], v[48:63]
  ds_read_b64_tr_b16 v[232:233], v242 offset:3584
  ds_read_b64_tr_b16 v[234:235], v243 offset:3584
  ds_read_b64_tr_b16 v[236:237], v246 offset:3584
  ds_read_b64_tr_b16 v[238:239], v247 offset:3584
  s_waitcnt lgkmcnt(4)
  v_mfma_f32_32x32x16_bf16 v[32:47], v[224:227], v[200:203], v[32:47]
  v_mfma_f32_32x32x16_bf16 v[48:63], v[228:231], v[200:203], v[48:63]
  ds_read_b64_tr_b16 v[224:225], v240 offset:7168
  ds_read_b64_tr_b16 v[226:227], v241 offset:7168
  ds_read_b64_tr_b16 v[228:229], v244 offset:7168
  ds_read_b64_tr_b16 v[230:231], v245 offset:7168
  s_waitcnt lgkmcnt(4)
  v_mfma_f32_32x32x16_bf16 v[32:47], v[232:235], v[204:207], v[32:47]
  v_mfma_f32_32x32x16_bf16 v[48:63], v[236:239], v[204:207], v[48:63]
  ds_read_b64_tr_b16 v[232:233], v242 offset:7168
  ds_read_b64_tr_b16 v[234:235], v243 offset:7168
  ds_read_b64_tr_b16 v[236:237], v246 offset:7168
  ds_read_b64_tr_b16 v[238:239], v247 offset:7168
  s_waitcnt lgkmcnt(4)
  v_mfma_f32_32x32x16_bf16 v[32:47], v[224:227], v[208:211], v[32:47]
  v_mfma_f32_32x32x16_bf16 v[48:63], v[228:231], v[208:211], v[48:63]
  ds_read_b64_tr_b16 v[224:225], v240 offset:10752
  ds_read_b64_tr_b16 v[226:227], v241 offset:10752
  ds_read_b64_tr_b16 v[228:229], v244 offset:10752
  ds_read_b64_tr_b16 v[230:231], v245 offset:10752
  s_waitcnt lgkmcnt(4)
  v_mfma_f32_32x32x16_bf16 v[32:47], v[232:235], v[212:215], v[32:47]
  v_mfma_f32_32x32x16_bf16 v[48:63], v[236:239], v[212:215], v[48:63]
  ds_read_b64_tr_b16 v[232:233], v242 offset:10752
  ds_read_b64_tr_b16 v[234:235], v243 offset:10752
  ds_read_b64_tr_b16 v[236:237], v246 offset:10752
  ds_read_b64_tr_b16 v[238:239], v247 offset:10752
  s_waitcnt lgkmcnt(4)
  v_mfma_f32_32x32x16_bf16 v[32:47], v[224:227], v[216:219], v[32:47]
  v_mfma_f32_32x32x16_bf16 v[48:63], v[228:231], v[216:219], v[48:63]
  s_waitcnt lgkmcnt(0)
  v_mfma_f32_32x32x16_bf16 v[32:47], v[232:235], v[220:223], v[32:47]
  v_mfma_f32_32x32x16_bf16 v[48:63], v[236:239], v[220:223], v[48:63]
  s_nop 11
  s_sub_u32 s34, s32, 1
  s_and_b32 s34, s34, 3
  s_cmp_eq_u32 s34, 3
  s_cbranch_scc1 LR60
  s_lshl_b32 s34, s34, 11
  s_mul_i32 s35, s57, 6144
  s_add_u32 s34, s34, s35
  s_add_u32 s34, s34, 106496
  v_add_u32 v10, s34, v8
  ds_write_b128 v10, v[32:35]
  ds_write_b128 v10, v[36:39] offset:1024
  s_branch LR61
LR60:
  v_mov_b32 v96, v32
  v_mov_b32 v97, v33
  v_mov_b32 v98, v34
  v_mov_b32 v99, v35
  v_mov_b32 v100, v36
  v_mov_b32 v101, v37
  v_mov_b32 v102, v38
  v_mov_b32 v103, v39
LR61:
  s_sub_u32 s34, s32, 2
  s_and_b32 s34, s34, 3
  s_cmp_eq_u32 s34, 3
  s_cbranch_scc1 LR62
  s_lshl_b32 s34, s34, 11
  s_mul_i32 s35, s57, 6144
  s_add_u32 s34, s34, s35
  s_add_u32 s34, s34, 118784
  v_add_u32 v10, s34, v8
  ds_write_b128 v10, v[40:43]
  ds_write_b128 v10, v[44:47] offset:1024
  s_branch LR63
LR62:
  v_mov_b32 v96, v40
  v_mov_b32 v97, v41
  v_mov_b32 v98, v42
  v_mov_b32 v99, v43
  v_mov_b32 v100, v44
  v_mov_b32 v101, v45
  v_mov_b32 v102, v46
  v_mov_b32 v103, v47
LR63:
  s_sub_u32 s34, s32, 3
  s_and_b32 s34, s34, 3
  s_cmp_eq_u32 s34, 3
  s_cbranch_scc1 LR64
  s_lshl_b32 s34, s34, 11
  s_mul_i32 s35, s57, 6144
  s_add_u32 s34, s34, s35
  s_add_u32 s34, s34, 131072
  v_add_u32 v10, s34, v8
  ds_write_b128 v10, v[48:51]
  ds_write_b128 v10, v[52:55] offset:1024
  s_branch LR65
LR64:
  v_mov_b32 v96, v48
  v_mov_b32 v97, v49
  v_mov_b32 v98, v50
  v_mov_b32 v99, v51
  v_mov_b32 v100, v52
  v_mov_b32 v101, v53
  v_mov_b32 v102, v54
  v_mov_b32 v103, v55
LR65:
  s_sub_u32 s34, s32, 4
  s_and_b32 s34, s34, 3
  s_cmp_eq_u32 s34, 3
  s_cbranch_scc1 LR66
  s_lshl_b32 s34, s34, 11
  s_mul_i32 s35, s57, 6144
  s_add_u32 s34, s34, s35
  s_add_u32 s34, s34, 143360
  v_add_u32 v10, s34, v8
  ds_write_b128 v10, v[56:59]
  ds_write_b128 v10, v[60:63] offset:1024
  s_branch LR67
LR66:
  v_mov_b32 v96, v56
  v_mov_b32 v97, v57
  v_mov_b32 v98, v58
  v_mov_b32 v99, v59
  v_mov_b32 v100, v60
  v_mov_b32 v101, v61
  v_mov_b32 v102, v62
  v_mov_b32 v103, v63
LR67:
  s_waitcnt lgkmcnt(0)
  s_barrier
  s_mul_i32 s34, s31, 6144
  s_add_u32 s34, s34, 106496
  v_add_u32 v10, s34, v8
  ds_read_b128 v[104:107], v10 offset:0
  ds_read_b128 v[108:111], v10 offset:1024
  ds_read_b128 v[112:115], v10 offset:2048
  ds_read_b128 v[116:119], v10 offset:3072
  ds_read_b128 v[120:123], v10 offset:4096
  ds_read_b128 v[124:127], v10 offset:5120
  s_waitcnt lgkmcnt(2)
  v_add_f32 v96, v96, v104
  v_add_f32 v97, v97, v105
  v_add_f32 v98, v98, v106
  v_add_f32 v99, v99, v107
  v_add_f32 v100, v100, v108
  v_add_f32 v101, v101, v109
  v_add_f32 v102, v102, v110
  v_add_f32 v103, v103, v111
  s_waitcnt lgkmcnt(0)
  v_add_f32 v112, v112, v120
  v_add_f32 v113, v113, v121
  v_add_f32 v114, v114, v122
  v_add_f32 v115, v115, v123
  v_add_f32 v116, v116, v124
  v_add_f32 v117, v117, v125
  v_add_f32 v118, v118, v126
  v_add_f32 v119, v119, v127
  v_add_f32 v96, v96, v112
  v_add_f32 v97, v97, v113
  v_add_f32 v98, v98, v114
  v_add_f32 v99, v99, v115
  v_add_f32 v100, v100, v116
  v_add_f32 v101, v101, v117
  v_add_f32 v102, v102, v118
  v_add_f32 v103, v103, v119
  v_cvt_pk_bf16_f32 v104, v96, v97
  v_cvt_pk_bf16_f32 v105, v98, v99
  v_cvt_pk_bf16_f32 v106, v100, v101
  v_cvt_pk_bf16_f32 v107, v102, v103
  s_nop 1
  v_permlane32_swap_b32 v104, v106
  v_permlane32_swap_b32 v105, v107
  buffer_store_dwordx4 v[104:107], v248, s[44:47], s70 offen
L_FIN:
L_END:
  s_endpgm
L_SLOW:
  buffer_store_dwordx4 v[36:39], v8, s[24:27], s59 offen sc1
  buffer_store_dwordx4 v[36:39], v8, s[24:27], s58 offen offset:0 sc1
  buffer_store_dwordx4 v[36:39], v8, s[24:27], s58 offen offset:1024 sc1
  s_waitcnt vmcnt(0)
  s_lshl_b32 s34, s56, 4
  s_add_u32 s34, s34, s55
  s_lshl_b32 s34, s34, 3
  s_add_u32 s34, s34, s31
  s_lshl_b32 s34, s34, 3
  s_add_u32 s34, s34, 17858560
  v_mov_b32 v14, s50
  v_mov_b32 v15, s51
  s_mov_b64 exec, 1
  buffer_store_dwordx2 v[14:15], v9, s[24:27], s34 offen sc0 sc1
  s_mov_b64 exec, -1
  s_add_u32 m0, s36, 106496
  s_mov_b32 s43, 0
  buffer_load_dwordx4 v4, s[20:23], s43 offen lds
  s_add_u32 m0, s36, 114688
  s_mov_b32 s43, 57344
  buffer_load_dwordx4 v4, s[20:23], s43 offen lds
  s_add_u32 m0, s36, 122880
  s_mov_b32 s43, 114688
  buffer_load_dwordx4 v4, s[20:23], s43 offen lds
  s_add_u32 m0, s36, 131072
  s_mov_b32 s43, 172032
  buffer_load_dwordx4 v4, s[20:23], s43 offen lds
  s_add_u32 m0, s36, 139264
  s_mov_b32 s43, 229376
  buffer_load_dwordx4 v4, s[20:23], s43 offen lds
  s_add_u32 m0, s36, 147456
  s_mov_b32 s43, 286720
  buffer_load_dwordx4 v4, s[20:23], s43 offen lds
  s_add_u32 m0, s36, 155648
  s_mov_b32 s43, 344064
  buffer_load_dwordx4 v4, s[20:23], s43 offen lds
  s_add_u32 m0, s36, 49152
  s_mov_b32 s43, 0
  buffer_load_dwordx4 v4, s[16:19], s43 offen lds
  s_add_u32 m0, s36, 57344
  s_mov_b32 s43, 57344
  buffer_load_dwordx4 v4, s[16:19], s43 offen lds
  s_add_u32 m0, s36, 65536
  s_mov_b32 s43, 114688
  buffer_load_dwordx4 v4, s[16:19], s43 offen lds
  s_add_u32 m0, s36, 73728
  s_mov_b32 s43, 172032
  buffer_load_dwordx4 v4, s[16:19], s43 offen lds
  s_add_u32 m0, s36, 81920
  s_mov_b32 s43, 229376
  buffer_load_dwordx4 v4, s[16:19], s43 offen lds
  s_add_u32 m0, s36, 90112
  s_mov_b32 s43, 286720
  buffer_load_dwordx4 v4, s[16:19], s43 offen lds
  s_add_u32 m0, s36, 98304
  s_mov_b32 s43, 344064
  buffer_load_dwordx4 v4, s[16:19], s43 offen lds
L_S1:
  v_mov_b32 v10, 0xff800000
  v_mov_b32 v11, 0xff800000
  s_mov_b32 s43, 0
L_S2:
  s_lshl_b32 s42, s43, 15
  s_xor_b32 s42, s42, s70
  buffer_load_dwordx4 v[192:195], v8, s[24:27], s42 offen sc1
  buffer_load_dwordx4 v[196:199], v8, s[24:27], s42 offen offset:1024 sc1
  s_waitcnt vmcnt(0)
  v_mfma_f32_32x32x16_bf16 v[96:111], v[192:195], v[16:19], 0
  v_mfma_f32_32x32x16_bf16 v[96:111], v[196:199], v[20:23], v[96:111]
  v_mfma_f32_32x32x16_bf16 v[112:127], v[192:195], v[24:27], 0
  v_mfma_f32_32x32x16_bf16 v[112:127], v[196:199], v[28:31], v[112:127]
  s_nop 15
  v_max3_f32 v10, v10, v96, v97
  v_max3_f32 v10, v10, v98, v99
  v_max3_f32 v10, v10, v100, v101
  v_max3_f32 v10, v10, v102, v103
  v_max3_f32 v10, v10, v104, v105
  v_max3_f32 v10, v10, v106, v107
  v_max3_f32 v10, v10, v108, v109
  v_max3_f32 v10, v10, v110, v111
  v_max3_f32 v11, v11, v112, v113
  v_max3_f32 v11, v11, v114, v115
  v_max3_f32 v11, v11, v116, v117
  v_max3_f32 v11, v11, v118, v119
  v_max3_f32 v11, v11, v120, v121
  v_max3_f32 v11, v11, v122, v123
  v_max3_f32 v11, v11, v124, v125
  v_max3_f32 v11, v11, v126, v127
  s_add_u32 s43, s43, 1
  s_cmp_lg_u32 s43, 16
  s_cbranch_scc1 L_S2
  v_mov_b32 v14, v10
  v_mov_b32 v15, v11
  s_nop 1
  v_permlane32_swap_b32 v10, v14
  v_permlane32_swap_b32 v11, v15
  v_max_f32 v10, v10, v14
  v_max_f32 v11, v11, v15
  s_barrier
  s_lshl_b32 s34, s31, 9
  s_add_u32 s34, s34, 0
  v_add_u32 v12, s34, v13
  ds_write_b32 v12, v10
  ds_write_b32 v12, v11 offset:256
  s_lshl_b32 s34, s61, 11
  s_add_u32 s34, s34, 0
  v_add_u32 v12, s34, v13
  s_waitcnt lgkmcnt(0)
  s_barrier
  ds_read_b32 v192, v12 offset:0
  ds_read_b32 v196, v12 offset:256
  ds_read_b32 v193, v12 offset:512
  ds_read_b32 v197, v12 offset:768
  ds_read_b32 v194, v12 offset:1024
  ds_read_b32 v198, v12 offset:1280
  ds_read_b32 v195, v12 offset:1536
  ds_read_b32 v199, v12 offset:1792
  s_waitcnt lgkmcnt(0)
  s_barrier
  v_max3_f32 v192, v192, v193, v194
  v_max_f32 v10, v192, v195
  v_max3_f32 v196, v196, v197, v198
  v_max_f32 v11, v196, v199
  v_mov_b32 v64, 0
  v_mov_b32 v65, 0
  v_mov_b32 v66, 0
  v_mov_b32 v67, 0
  v_mov_b32 v68, 0
  v_mov_b32 v69, 0
  v_mov_b32 v70, 0
  v_mov_b32 v71, 0
  v_mov_b32 v72, 0
  v_mov_b32 v73, 0
  v_mov_b32 v74, 0
  v_mov_b32 v75, 0
  v_mov_b32 v76, 0
  v_mov_b32 v77, 0
  v_mov_b32 v78, 0
  v_mov_b32 v79, 0
  v_mov_b32 v80, 0
  v_mov_b32 v81, 0
  v_mov_b32 v82, 0
  v_mov_b32 v83, 0
  v_mov_b32 v84, 0
  v_mov_b32 v85, 0
  v_mov_b32 v86, 0
  v_mov_b32 v87, 0
  v_mov_b32 v88, 0
  v_mov_b32 v89, 0
  v_mov_b32 v90, 0
  v_mov_b32 v91, 0
  v_mov_b32 v92, 0
  v_mov_b32 v93, 0
  v_mov_b32 v94, 0
  v_mov_b32 v95, 0
  s_mov_b32 s43, 0
L_S3:
  s_lshl_b32 s42, s43, 15
  s_xor_b32 s42, s42, s70
  s_lshl_b32 s37, s43, 11
  s_xor_b32 s37, s37, s71
  buffer_load_dwordx4 v[192:195], v8, s[24:27], s42 offen sc1
  buffer_load_dwordx4 v[196:199], v8, s[24:27], s42 offen offset:1024 sc1
  buffer_load_dwordx4 v[200:203], v5, s[24:27], s37 offen sc1
  buffer_load_dwordx4 v[204:207], v5, s[24:27], s37 offen offset:1024 sc1
  s_waitcnt vmcnt(0)
  v_mfma_f32_32x32x16_bf16 v[96:111], v[192:195], v[16:19], 0
  v_mfma_f32_32x32x16_bf16 v[96:111], v[196:199], v[20:23], v[96:111]
  v_mfma_f32_32x32x16_bf16 v[112:127], v[192:195], v[24:27], 0
  v_mfma_f32_32x32x16_bf16 v[112:127], v[196:199], v[28:31], v[112:127]
  s_nop 15
  v_sub_f32 v96, v96, v10
  v_sub_f32 v97, v97, v10
  v_sub_f32 v98, v98, v10
  v_sub_f32 v99, v99, v10
  v_sub_f32 v100, v100, v10
  v_sub_f32 v101, v101, v10
  v_sub_f32 v102, v102, v10
  v_sub_f32 v103, v103, v10
  v_sub_f32 v104, v104, v10
  v_sub_f32 v105, v105, v10
  v_sub_f32 v106, v106, v10
  v_sub_f32 v107, v107, v10
  v_sub_f32 v108, v108, v10
  v_sub_f32 v109, v109, v10
  v_sub_f32 v110, v110, v10
  v_sub_f32 v111, v111, v10
  v_exp_f32 v96, v96
  v_exp_f32 v97, v97
  v_exp_f32 v98, v98
  v_exp_f32 v99, v99
  v_exp_f32 v100, v100
  v_exp_f32 v101, v101
  v_exp_f32 v102, v102
  v_exp_f32 v103, v103
  v_exp_f32 v104, v104
  v_exp_f32 v105, v105
  v_exp_f32 v106, v106
  v_exp_f32 v107, v107
  v_exp_f32 v108, v108
  v_exp_f32 v109, v109
  v_exp_f32 v110, v110
  v_exp_f32 v111, v111
  s_nop 0
  v_cvt_pk_bf16_f32 v128, v96, v97
  v_cvt_pk_bf16_f32 v129, v98, v99
  v_cvt_pk_bf16_f32 v130, v100, v101
  v_cvt_pk_bf16_f32 v131, v102, v103
  v_cvt_pk_bf16_f32 v132, v104, v105
  v_cvt_pk_bf16_f32 v133, v106, v107
  v_cvt_pk_bf16_f32 v134, v108, v109
  v_cvt_pk_bf16_f32 v135, v110, v111
  v_sub_f32 v112, v112, v11
  v_sub_f32 v113, v113, v11
  v_sub_f32 v114, v114, v11
  v_sub_f32 v115, v115, v11
  v_sub_f32 v116, v116, v11
  v_sub_f32 v117, v117, v11
  v_sub_f32 v118, v118, v11
  v_sub_f32 v119, v119, v11
  v_sub_f32 v120, v120, v11
  v_sub_f32 v121, v121, v11
  v_sub_f32 v122, v122, v11
  v_sub_f32 v123, v123, v11
  v_sub_f32 v124, v124, v11
  v_sub_f32 v125, v125, v11
  v_sub_f32 v126, v126, v11
  v_sub_f32 v127, v127, v11
  v_exp_f32 v112, v112
  v_exp_f32 v113, v113
  v_exp_f32 v114, v114
  v_exp_f32 v115, v115
  v_exp_f32 v116, v116
  v_exp_f32 v117, v117
  v_exp_f32 v118, v118
  v_exp_f32 v119, v119
  v_exp_f32 v120, v120
  v_exp_f32 v121, v121
  v_exp_f32 v122, v122
  v_exp_f32 v123, v123
  v_exp_f32 v124, v124
  v_exp_f32 v125, v125
  v_exp_f32 v126, v126
  v_exp_f32 v127, v127
  s_nop 0
  v_cvt_pk_bf16_f32 v136, v112, v113
  v_cvt_pk_bf16_f32 v137, v114, v115
  v_cvt_pk_bf16_f32 v138, v116, v117
  v_cvt_pk_bf16_f32 v139, v118, v119
  v_cvt_pk_bf16_f32 v140, v120, v121
  v_cvt_pk_bf16_f32 v141, v122, v123
  v_cvt_pk_bf16_f32 v142, v124, v125
  v_cvt_pk_bf16_f32 v143, v126, v127
  s_nop 1
  v_mfma_f32_32x32x16_bf16 v[64:79], v[200:203], v[128:131], v[64:79]
  v_mfma_f32_32x32x16_bf16 v[64:79], v[204:207], v[132:135], v[64:79]
  v_mfma_f32_32x32x16_bf16 v[80:95], v[200:203], v[136:139], v[80:95]
  v_mfma_f32_32x32x16_bf16 v[80:95], v[204:207], v[140:143], v[80:95]
  s_add_u32 s43, s43, 1
  s_cmp_lg_u32 s43, 16
  s_cbranch_scc1 L_S3
  s_cmp_lt_u32 s31, 4
  s_cbranch_scc0 L_S4
  s_mul_i32 s33, s55, 7
  s_lshr_b32 s34, s33, 4
  s_add_u32 s35, s33, 6
  s_lshr_b32 s35, s35, 4
  s_sub_u32 s35, s35, s34
  s_lshl_b32 s35, s35, 11
  s_lshl_b32 s34, s34, 11
  s_lshl_b32 s33, s56, 7
  s_add_u32 s34, s34, s33
  s_add_u32 s34, s34, 17842176
  v_and_b32 v10, 1, v1
  v_mul_u32_u24 v10, s35, v10
  v_add_u32 v10, s34, v10
  s_lshl_b32 s33, s55, 7
  s_add_u32 s33, s33, 16842752
  buffer_load_dword v14, v9, s[24:27], s33 offen sc1
  buffer_load_dwordx2 v[6:7], v10, s[24:27], 0 offen sc1
  s_waitcnt vmcnt(0)
  s_mov_b32 s52, 20000
LP68:
  v_cmp_gt_u32 s[48:49], 16, v14
  v_cmp_ne_u64 s[34:35], s[50:51], v[6:7]
  s_nop 0
  s_or_b64 s[48:49], s[48:49], s[34:35]
  s_cmp_eq_u64 s[48:49], 0
  s_cbranch_scc1 LD69
  s_sub_u32 s52, s52, 1
  s_cbranch_scc1 LD69
  s_sleep 4
  buffer_load_dword v14, v9, s[24:27], s33 offen sc1
  buffer_load_dwordx2 v[6:7], v10, s[24:27], 0 offen sc1
  s_waitcnt vmcnt(0)
  s_branch LP68
LD69:
  s_lshl_b32 s34, s55, 12
  s_add_u32 s34, s34, 16777216
  s_lshl_b32 s35, s56, 2
  s_add_u32 s35, s35, s60
  s_mul_i32 s35, s35, 28672
  s_add_u32 s35, s35, s29
  s_add_u32 s35, s35, 6291456
  buffer_load_dword v144, v13, s[24:27], s34 offen offset:0 sc1
  buffer_load_dword v145, v13, s[24:27], s34 offen offset:256 sc1
  buffer_load_dword v146, v13, s[24:27], s34 offen offset:512 sc1
  buffer_load_dword v147, v13, s[24:27], s34 offen offset:768 sc1
  buffer_load_dword v148, v13, s[24:27], s34 offen offset:1024 sc1
  buffer_load_dword v149, v13, s[24:27], s34 offen offset:1280 sc1
  buffer_load_dword v150, v13, s[24:27], s34 offen offset:1536 sc1
  buffer_load_dword v151, v13, s[24:27], s34 offen offset:1792 sc1
  buffer_load_dword v152, v13, s[24:27], s34 offen offset:2048 sc1
  buffer_load_dword v153, v13, s[24:27], s34 offen offset:2304 sc1
  buffer_load_dword v154, v13, s[24:27], s34 offen offset:2560 sc1
  buffer_load_dword v155, v13, s[24:27], s34 offen offset:2816 sc1
  buffer_load_dword v156, v13, s[24:27], s34 offen offset:3072 sc1
  buffer_load_dword v157, v13, s[24:27], s34 offen offset:3328 sc1
  buffer_load_dword v158, v13, s[24:27], s34 offen offset:3584 sc1
  buffer_load_dword v159, v13, s[24:27], s34 offen offset:3840 sc1
  buffer_load_dwordx4 v[168:171], v8, s[24:27], s35 offen offset:0 sc1
  buffer_load_dwordx4 v[172:175], v8, s[24:27], s35 offen offset:1024 sc1
  s_waitcnt vmcnt(0)
  v_cvt_pk_bf16_f32 v160, v144, v145
  v_cvt_pk_bf16_f32 v161, v146, v147
  v_cvt_pk_bf16_f32 v162, v148, v149
  v_cvt_pk_bf16_f32 v163, v150, v151
  v_cvt_pk_bf16_f32 v164, v152, v153
  v_cvt_pk_bf16_f32 v165, v154, v155
  v_cvt_pk_bf16_f32 v166, v156, v157
  v_cvt_pk_bf16_f32 v167, v158, v159
  v_cndmask_b32 v168, v168, 0, s[38:39]
  v_cndmask_b32 v169, v169, 0, s[38:39]
  v_cndmask_b32 v174, v174, 0, s[40:41]
  v_cndmask_b32 v175, v175, 0, s[40:41]
  s_nop 1
  v_mfma_f32_32x32x16_bf16 v[176:191], v[160:163], v[168:171], 0
  v_mfma_f32_32x32x16_bf16 v[176:191], v[164:167], v[172:175], v[176:191]
  s_nop 15
  v_add_f32 v15, 897988541, v183
  v_rcp_f32 v15, v15
  s_nop 0
  v_mul_f32 v176, v176, v15
  v_mul_f32 v177, v177, v15
  v_mul_f32 v178, v178, v15
  v_mul_f32 v179, v179, v15
  v_mul_f32 v180, v180, v15
  v_mul_f32 v181, v181, v15
  v_mul_f32 v182, v182, v15
  v_mov_b32 v183, 8388608
  v_mul_f32 v184, v184, v15
  v_mul_f32 v185, v185, v15
  v_mul_f32 v186, v186, v15
  v_mul_f32 v187, v187, v15
  v_mul_f32 v188, v188, v15
  v_mul_f32 v189, v189, v15
  v_mul_f32 v190, v190, v15
  v_mov_b32 v191, 8388608
  v_cvt_pk_bf16_f32 v160, v176, v177
  v_cvt_pk_bf16_f32 v161, v178, v179
  v_cvt_pk_bf16_f32 v162, v180, v181
  v_cvt_pk_bf16_f32 v163, v182, v183
  v_cvt_pk_bf16_f32 v164, v184, v185
  v_cvt_pk_bf16_f32 v165, v186, v187
  v_cvt_pk_bf16_f32 v166, v188, v189
  v_cvt_pk_bf16_f32 v167, v190, v191
  buffer_store_dwordx4 v[160:163], v8, s[24:27], s58 offen offset:0 sc1
  buffer_store_dwordx4 v[164:167], v8, s[24:27], s58 offen offset:1024 sc1
L_S4:
  buffer_load_dwordx4 v[32:35], v0, s[24:27], 0 offen sc1
  s_waitcnt vmcnt(0)
  s_mov_b32 s52, 20000
LP70:
  v_cmp_ne_u64 s[48:49], s[50:51], v[32:33]
  v_cmp_ne_u64 s[34:35], s[50:51], v[34:35]
  s_nop 0
  s_or_b64 s[48:49], s[48:49], s[34:35]
  s_cmp_eq_u64 s[48:49], 0
  s_cbranch_scc1 LD71
  s_sub_u32 s52, s52, 1
  s_cbranch_scc1 LD71
  s_sleep 4
  buffer_load_dwordx4 v[32:35], v0, s[24:27], 0 offen sc1
  s_waitcnt vmcnt(0)
  s_branch LP70
LD71:
  s_branch L_TAIL
L_CEND:
.section .rodata,"a"
.p2align 6
.amdhsa_kernel concat_heads__softmax_full_mha__linear_attn_block__prompt_kernel
  .amdhsa_next_free_vgpr 256
  .amdhsa_next_free_sgpr 102
  .amdhsa_accum_offset 256
  .amdhsa_group_segment_fixed_size 0
  .amdhsa_kernarg_size 72
  .amdhsa_user_sgpr_count 2
  .amdhsa_user_sgpr_kernarg_segment_ptr 1
  .amdhsa_system_sgpr_workgroup_id_x 1
.end_amdhsa_kernel
```
